```python
import torch

def _softmax(x, axis=-1):
    return torch.softmax(x, dim=axis)
def _gelu(x):
    return torch.nn.functional.gelu(x, approximate="tanh")
def _silu(x):
    return torch.nn.functional.silu(x)
def _sigmoid(x):
    return torch.sigmoid(x)
def _layernorm(x, axis=-1, eps=1e-5):
    m = x.mean(dim=axis, keepdim=True)
    v = x.var(dim=axis, keepdim=True, unbiased=False)
    return (x - m) / torch.sqrt(v + eps)
def _scatter_add(tgt, idx, src, axis=0):
    return tgt.clone().index_add_(axis, idx, src)
def _segment_sum(src, seg, n):
    out = torch.zeros((n,) + src.shape[1:], dtype=src.dtype)
    return out.index_add_(0, seg, src)
def _pad(x, pw):
    flat = tuple(v for pair in reversed(pw) for v in pair)
    return torch.nn.functional.pad(x, flat)

kernel_name = 'concat_heads__gqa_block_cached__gqa_block_cached__decode'

def setup_inputs():

    _w = (lambda a: (lambda t: t.to(torch.bfloat16) if t.is_floating_point() else t)(torch.as_tensor(a)))
    def _A_setup():
        B, Sq, D = 1, 1, 512
        Hq, Hkv, Sk, Dh = 32, 8, 65536, 128
        assert Hq % Hkv == 0, (Hq, Hkv)
        return {
            "x": _w((lambda *s: torch.randn(*s, dtype=torch.bfloat16) * 0.8)(B, Sq, D)),
            "k_cache": _w((lambda *s: torch.randn(*s, dtype=torch.bfloat16) * 1.6)(B, Hkv, Sk, Dh)),
            "v_cache": _w((lambda *s: torch.randn(*s, dtype=torch.bfloat16) * 0.2)(B, Hkv, Sk, Dh)),
            "wq": _w((lambda *s: torch.randn(*s, dtype=torch.bfloat16) * 1.6)(D, Hq * Dh) * (D ** -0.5)),
            "wo": _w((lambda *s: torch.randn(*s, dtype=torch.bfloat16) * 0.2)(Hq * Dh, D) * ((Hq * Dh) ** -0.5)),
        }
    _A_in = _A_setup()

    def _B_setup():
        B, Sq, D = 1, 1, 512
        Hq, Hkv, Sk, Dh = 32, 8, 65536, 128
        assert Hq % Hkv == 0, (Hq, Hkv)
        return {
            "x": _w((lambda *s: torch.randn(*s, dtype=torch.bfloat16) * 0.8)(B, Sq, D)),
            "k_cache": _w((lambda *s: torch.randn(*s, dtype=torch.bfloat16) * 1.6)(B, Hkv, Sk, Dh)),
            "v_cache": _w((lambda *s: torch.randn(*s, dtype=torch.bfloat16) * 0.2)(B, Hkv, Sk, Dh)),
            "wq": _w((lambda *s: torch.randn(*s, dtype=torch.bfloat16) * 1.6)(D, Hq * Dh) * (D ** -0.5)),
            "wo": _w((lambda *s: torch.randn(*s, dtype=torch.bfloat16) * 0.2)(Hq * Dh, D) * ((Hq * Dh) ** -0.5)),
        }
    _B_in = _B_setup()

    return {
        "A_x": _A_in["x"],
        "A_k_cache": _A_in["k_cache"],
        "A_v_cache": _A_in["v_cache"],
        "A_wq": _A_in["wq"],
        "A_wo": _A_in["wo"],
        "B_x": _B_in["x"],
        "B_k_cache": _B_in["k_cache"],
        "B_v_cache": _B_in["v_cache"],
        "B_wq": _B_in["wq"],
        "B_wo": _B_in["wo"],
    }

def reference(A_x, A_k_cache, A_v_cache, A_wq, A_wo, B_x, B_k_cache, B_v_cache, B_wq, B_wo):
    def _A_ref(x, k_cache, v_cache, wq, wo):
        B, Sq, D = x.shape
        Hq, Dh = 32, 128
        Hkv = k_cache.shape[1]
        rep = Hq // Hkv
        q = (lambda x, *d: x.permute(*d))((x @ wq).reshape(B, Sq, Hq, Dh), 0, 2, 1, 3)
        k = (lambda x, n, axis: torch.repeat_interleave(x, n, dim=axis))(k_cache, rep, axis=1)
        v = (lambda x, n, axis: torch.repeat_interleave(x, n, dim=axis))(v_cache, rep, axis=1)
        scores = torch.einsum("bhqd,bhkd->bhqk", q, k) * (Dh ** -0.5)
        p = _softmax(scores, axis=-1)
        o = torch.einsum("bhqk,bhkd->bhqd", p, v)
        return (lambda x, *d: x.permute(*d))(o, 0, 2, 1, 3).reshape(B, Sq, Hq * Dh) @ wo

    def _B_ref(x, k_cache, v_cache, wq, wo):
        B, Sq, D = x.shape
        Hq, Dh = 32, 128
        Hkv = k_cache.shape[1]
        rep = Hq // Hkv
        q = (lambda x, *d: x.permute(*d))((x @ wq).reshape(B, Sq, Hq, Dh), 0, 2, 1, 3)
        k = (lambda x, n, axis: torch.repeat_interleave(x, n, dim=axis))(k_cache, rep, axis=1)
        v = (lambda x, n, axis: torch.repeat_interleave(x, n, dim=axis))(v_cache, rep, axis=1)
        scores = torch.einsum("bhqd,bhkd->bhqk", q, k) * (Dh ** -0.5)
        p = _softmax(scores, axis=-1)
        o = torch.einsum("bhqk,bhkd->bhqd", p, v)
        return (lambda x, *d: x.permute(*d))(o, 0, 2, 1, 3).reshape(B, Sq, Hq * Dh) @ wo

    a = _A_ref(A_x, A_k_cache, A_v_cache, A_wq, A_wo)
    b = _B_ref(B_x, B_k_cache, B_v_cache, B_wq, B_wo)
    return torch.concatenate([a, b], axis=-1)
```

```asm
; @launch grid=(256,1,1) block=(320,1,1) lds=28992
.amdgcn_target "amdgcn-amd-amdhsa--gfx950"
.text
.globl concat_heads__gqa_block_cached__gqa_block_cached__decode_kernel
.p2align 8
.type concat_heads__gqa_block_cached__gqa_block_cached__decode_kernel,@function
concat_heads__gqa_block_cached__gqa_block_cached__decode_kernel:
    s_cmp_ge_u32 s2, 256
    s_cbranch_scc1 L_end
    s_lshr_b32 s5, s2, 7
    s_mul_i32 s7, s5, 40
    s_add_u32 s8, s0, s7
    s_addc_u32 s9, s1, 0
    s_load_dwordx2 s[12:13], s[8:9], 0
    s_load_dwordx4 s[16:19], s[8:9], 24
    s_load_dwordx4 s[80:83], s[0:1], 8
    s_load_dwordx4 s[84:87], s[0:1], 48
    s_load_dwordx2 s[10:11], s[0:1], 80
    s_load_dwordx2 s[22:23], s[0:1], 96
    s_and_b32 s3, s2, 7
    s_lshr_b32 s4, s2, 3
    v_lshrrev_b32 v2, 6, v0
    v_and_b32 v1, 63, v0
    v_readfirstlane_b32 s20, v2
    s_bfe_u32 s44, s2, 0x10006
    s_and_b32 s45, s4, 7
    s_lshl_b32 s36, s44, 8
    s_lshl_b32 s37, s20, 6
    s_add_u32 s36, s36, s37
    v_and_b32 v4, 56, v1
    v_add_u32 v4, s36, v4
    s_lshl_b32 s37, s3, 10
    s_lshl_b32 s38, s45, 7
    s_add_u32 s37, s37, s38
    v_and_b32 v5, 7, v1
    v_lshlrev_b32 v5, 4, v5
    v_add_u32 v5, s37, v5
    v_lshl_add_u32 v5, v4, 13, v5
    v_lshlrev_b32 v4, 1, v4
    v_lshlrev_b32 v3, 4, v1
    s_mov_b32 s74, 1024
    s_mov_b32 s75, 0x20000
    s_mov_b32 s66, 4194304
    s_mov_b32 s67, 0x20000
    s_mov_b32 s26, 134217728
    s_mov_b32 s27, 0x20000
    s_mov_b32 s34, 553650176
    s_mov_b32 s35, 0x20000
    s_mov_b32 s70, 4194304
    s_mov_b32 s71, 0x20000
    s_mov_b32 s78, 2048
    s_mov_b32 s79, 0x20000
    s_waitcnt lgkmcnt(0)
    s_mov_b32 s72, s12
    s_and_b32 s73, s13, 0xffff
    s_mov_b32 s64, s16
    s_and_b32 s65, s17, 0xffff
    s_cmp_eq_u32 s20, 4
    s_cbranch_scc1 L_nold
    buffer_load_dwordx4 v[8:11], v4, s[72:75], 0 offen
    buffer_load_dwordx4 v[12:15], v5, s[64:67], 0 offen nt
    s_mov_b32 s36, 8192
    buffer_load_dwordx4 v[16:19], v5, s[64:67], s36 offen nt
    s_mov_b32 s36, 16384
    buffer_load_dwordx4 v[20:23], v5, s[64:67], s36 offen nt
    s_mov_b32 s36, 24576
    buffer_load_dwordx4 v[24:27], v5, s[64:67], s36 offen nt
    s_mov_b32 s36, 32768
    buffer_load_dwordx4 v[28:31], v5, s[64:67], s36 offen nt
    s_mov_b32 s36, 40960
    buffer_load_dwordx4 v[32:35], v5, s[64:67], s36 offen nt
    s_mov_b32 s36, 49152
    buffer_load_dwordx4 v[36:39], v5, s[64:67], s36 offen nt
    s_mov_b32 s36, 57344
    buffer_load_dwordx4 v[40:43], v5, s[64:67], s36 offen nt
L_nold:
    s_load_dword s47, s[22:23], 65536
    s_and_b32 s81, s81, 0xffff
    s_and_b32 s83, s83, 0xffff
    s_and_b32 s85, s85, 0xffff
    s_and_b32 s87, s87, 0xffff
    s_mov_b32 s24, s80
    s_mov_b32 s25, s81
    s_mov_b32 s32, s22
    s_and_b32 s33, s23, 0xffff
    s_mov_b32 s68, s18
    s_and_b32 s69, s19, 0xffff
    s_mov_b32 s76, s10
    s_and_b32 s77, s11, 0xffff
    s_bfe_u32 s62, s2, 0x30000
    s_bfe_u32 s63, s2, 0x50003
    s_mov_b32 s21, 0
    s_bitcmp1_b32 s20, 0
    s_cselect_b32 s6, 0x180100, 0
    s_xor_b32 s21, s21, s6
    s_bitcmp1_b32 s20, 1
    s_cselect_b32 s6, 0x200, 0
    s_xor_b32 s21, s21, s6
    s_bitcmp1_b32 s2, 0
    s_cselect_b32 s6, 0x1000000, 0
    s_xor_b32 s21, s21, s6
    s_bitcmp1_b32 s2, 1
    s_cselect_b32 s6, 0x2081000, 0
    s_xor_b32 s21, s21, s6
    s_bitcmp1_b32 s2, 2
    s_cselect_b32 s6, 0x40e5000, 0
    s_xor_b32 s21, s21, s6
    s_bitcmp1_b32 s2, 3
    s_cselect_b32 s6, 0x44800, 0
    s_xor_b32 s21, s21, s6
    s_bitcmp1_b32 s2, 4
    s_cselect_b32 s6, 0x444100, 0
    s_xor_b32 s21, s21, s6
    s_bitcmp1_b32 s2, 5
    s_cselect_b32 s6, 0x200100, 0
    s_xor_b32 s21, s21, s6
    s_bitcmp1_b32 s2, 6
    s_cselect_b32 s6, 0x10100, 0
    s_xor_b32 s21, s21, s6
    s_bitcmp1_b32 s2, 7
    s_cselect_b32 s6, 0x804100, 0
    s_xor_b32 s21, s21, s6
    s_bfe_u32 s42, s2, 0x30000
    s_lshl_b32 s42, s42, 19
    s_bfe_u32 s6, s2, 0x20003
    s_lshl_b32 s6, s6, 8
    s_or_b32 s42, s42, s6
    s_bfe_u32 s6, s2, 0x20005
    s_lshl_b32 s6, s6, 17
    s_or_b32 s42, s42, s6
    s_and_b32 s43, s20, 3
    s_lshl_b32 s43, s43, 15
    s_or_b32 s42, s42, s43
    s_mov_b32 s58, 0xf00f00
    s_mov_b32 s59, 0xf00f
    s_cmp_eq_u32 s20, 4
    s_cbranch_scc1 L_helper
L_stream:
    v_and_b32 v2, 3, v1
    v_lshlrev_b32 v2, 4, v2
    v_lshrrev_b32 v52, 4, v1
    v_lshl_add_u32 v2, v52, 6, v2
    v_bfe_u32 v52, v1, 2, 1
    v_lshl_add_u32 v7, v52, 10, v2
    v_bfe_u32 v52, v1, 3, 1
    v_lshl_add_u32 v7, v52, 15, v7
    v_mov_b32 v6, v7
    s_mov_b32 s43, s21
    s_mov_b32 s46, 0
    v_bfe_u32 v52, v1, 2, 2
    v_lshl_add_u32 v2, v52, 8, v2
    v_mov_b32 v44, 0
    v_mov_b32 v45, 0
    v_mov_b32 v46, 0
    v_mov_b32 v47, 0
    v_mov_b32 v48, 0
    v_mov_b32 v49, 0
    v_mov_b32 v50, 0
    v_mov_b32 v51, 0
    s_waitcnt vmcnt(7)
    v_lshlrev_b32 v52, 16, v8
    v_lshlrev_b32 v53, 16, v12
    v_fmac_f32 v44, v52, v53
    v_and_b32 v53, 0xffff0000, v12
    v_fmac_f32 v45, v52, v53
    v_lshlrev_b32 v53, 16, v13
    v_fmac_f32 v46, v52, v53
    v_and_b32 v53, 0xffff0000, v13
    v_fmac_f32 v47, v52, v53
    v_lshlrev_b32 v53, 16, v14
    v_fmac_f32 v48, v52, v53
    v_and_b32 v53, 0xffff0000, v14
    v_fmac_f32 v49, v52, v53
    v_lshlrev_b32 v53, 16, v15
    v_fmac_f32 v50, v52, v53
    v_and_b32 v53, 0xffff0000, v15
    v_fmac_f32 v51, v52, v53
    s_waitcnt vmcnt(6)
    v_and_b32 v52, 0xffff0000, v8
    v_lshlrev_b32 v53, 16, v16
    v_fmac_f32 v44, v52, v53
    v_and_b32 v53, 0xffff0000, v16
    v_fmac_f32 v45, v52, v53
    v_lshlrev_b32 v53, 16, v17
    v_fmac_f32 v46, v52, v53
    v_and_b32 v53, 0xffff0000, v17
    v_fmac_f32 v47, v52, v53
    v_lshlrev_b32 v53, 16, v18
    v_fmac_f32 v48, v52, v53
    v_and_b32 v53, 0xffff0000, v18
    v_fmac_f32 v49, v52, v53
    v_lshlrev_b32 v53, 16, v19
    v_fmac_f32 v50, v52, v53
    v_and_b32 v53, 0xffff0000, v19
    v_fmac_f32 v51, v52, v53
    s_waitcnt vmcnt(5)
    buffer_load_dwordx4 a[0:3], v6, s[24:27], s43 offen offset:0 nt
    v_lshlrev_b32 v52, 16, v9
    v_lshlrev_b32 v53, 16, v20
    v_fmac_f32 v44, v52, v53
    v_and_b32 v53, 0xffff0000, v20
    v_fmac_f32 v45, v52, v53
    v_lshlrev_b32 v53, 16, v21
    v_fmac_f32 v46, v52, v53
    v_and_b32 v53, 0xffff0000, v21
    v_fmac_f32 v47, v52, v53
    v_lshlrev_b32 v53, 16, v22
    v_fmac_f32 v48, v52, v53
    v_and_b32 v53, 0xffff0000, v22
    v_fmac_f32 v49, v52, v53
    v_lshlrev_b32 v53, 16, v23
    v_fmac_f32 v50, v52, v53
    v_and_b32 v53, 0xffff0000, v23
    v_fmac_f32 v51, v52, v53
    s_waitcnt vmcnt(5)
    s_xor_b32 s40, s43, 0x2000
    buffer_load_dwordx4 a[4:7], v6, s[24:27], s40 offen offset:0 nt
    v_and_b32 v52, 0xffff0000, v9
    v_lshlrev_b32 v53, 16, v24
    v_fmac_f32 v44, v52, v53
    v_and_b32 v53, 0xffff0000, v24
    v_fmac_f32 v45, v52, v53
    v_lshlrev_b32 v53, 16, v25
    v_fmac_f32 v46, v52, v53
    v_and_b32 v53, 0xffff0000, v25
    v_fmac_f32 v47, v52, v53
    v_lshlrev_b32 v53, 16, v26
    v_fmac_f32 v48, v52, v53
    v_and_b32 v53, 0xffff0000, v26
    v_fmac_f32 v49, v52, v53
    v_lshlrev_b32 v53, 16, v27
    v_fmac_f32 v50, v52, v53
    v_and_b32 v53, 0xffff0000, v27
    v_fmac_f32 v51, v52, v53
    s_waitcnt vmcnt(5)
    s_xor_b32 s40, s43, 0x40000
    buffer_load_dwordx4 a[8:11], v6, s[24:27], s40 offen offset:0 nt
    v_lshlrev_b32 v52, 16, v10
    v_lshlrev_b32 v53, 16, v28
    v_fmac_f32 v44, v52, v53
    v_and_b32 v53, 0xffff0000, v28
    v_fmac_f32 v45, v52, v53
    v_lshlrev_b32 v53, 16, v29
    v_fmac_f32 v46, v52, v53
    v_and_b32 v53, 0xffff0000, v29
    v_fmac_f32 v47, v52, v53
    v_lshlrev_b32 v53, 16, v30
    v_fmac_f32 v48, v52, v53
    v_and_b32 v53, 0xffff0000, v30
    v_fmac_f32 v49, v52, v53
    v_lshlrev_b32 v53, 16, v31
    v_fmac_f32 v50, v52, v53
    v_and_b32 v53, 0xffff0000, v31
    v_fmac_f32 v51, v52, v53
    s_waitcnt vmcnt(5)
    s_xor_b32 s40, s43, 0x42000
    buffer_load_dwordx4 a[12:15], v6, s[24:27], s40 offen offset:0 nt
    v_and_b32 v52, 0xffff0000, v10
    v_lshlrev_b32 v53, 16, v32
    v_fmac_f32 v44, v52, v53
    v_and_b32 v53, 0xffff0000, v32
    v_fmac_f32 v45, v52, v53
    v_lshlrev_b32 v53, 16, v33
    v_fmac_f32 v46, v52, v53
    v_and_b32 v53, 0xffff0000, v33
    v_fmac_f32 v47, v52, v53
    v_lshlrev_b32 v53, 16, v34
    v_fmac_f32 v48, v52, v53
    v_and_b32 v53, 0xffff0000, v34
    v_fmac_f32 v49, v52, v53
    v_lshlrev_b32 v53, 16, v35
    v_fmac_f32 v50, v52, v53
    v_and_b32 v53, 0xffff0000, v35
    v_fmac_f32 v51, v52, v53
    s_waitcnt vmcnt(5)
    s_xor_b32 s40, s43, 0x4000
    buffer_load_dwordx4 a[16:19], v6, s[24:27], s40 offen offset:0 nt
    v_lshlrev_b32 v52, 16, v11
    v_lshlrev_b32 v53, 16, v36
    v_fmac_f32 v44, v52, v53
    v_and_b32 v53, 0xffff0000, v36
    v_fmac_f32 v45, v52, v53
    v_lshlrev_b32 v53, 16, v37
    v_fmac_f32 v46, v52, v53
    v_and_b32 v53, 0xffff0000, v37
    v_fmac_f32 v47, v52, v53
    v_lshlrev_b32 v53, 16, v38
    v_fmac_f32 v48, v52, v53
    v_and_b32 v53, 0xffff0000, v38
    v_fmac_f32 v49, v52, v53
    v_lshlrev_b32 v53, 16, v39
    v_fmac_f32 v50, v52, v53
    v_and_b32 v53, 0xffff0000, v39
    v_fmac_f32 v51, v52, v53
    s_waitcnt vmcnt(5)
    s_xor_b32 s40, s43, 0x6000
    buffer_load_dwordx4 a[20:23], v6, s[24:27], s40 offen offset:0 nt
    s_xor_b32 s40, s43, 0x44000
    buffer_load_dwordx4 a[24:27], v6, s[24:27], s40 offen offset:0 nt
    s_xor_b32 s40, s43, 0x46000
    buffer_load_dwordx4 a[28:31], v6, s[24:27], s40 offen offset:0 nt
    v_and_b32 v52, 0xffff0000, v11
    v_lshlrev_b32 v53, 16, v40
    v_fmac_f32 v44, v52, v53
    v_and_b32 v53, 0xffff0000, v40
    v_fmac_f32 v45, v52, v53
    v_lshlrev_b32 v53, 16, v41
    v_fmac_f32 v46, v52, v53
    v_and_b32 v53, 0xffff0000, v41
    v_fmac_f32 v47, v52, v53
    v_lshlrev_b32 v53, 16, v42
    v_fmac_f32 v48, v52, v53
    v_and_b32 v53, 0xffff0000, v42
    v_fmac_f32 v49, v52, v53
    v_lshlrev_b32 v53, 16, v43
    v_fmac_f32 v50, v52, v53
    v_and_b32 v53, 0xffff0000, v43
    v_fmac_f32 v51, v52, v53
    v_and_b32 v54, 7, v1
    v_lshlrev_b32 v54, 5, v54
    v_permlane32_swap_b32 v44, v48
    v_permlane32_swap_b32 v45, v49
    v_permlane32_swap_b32 v46, v50
    v_permlane32_swap_b32 v47, v51
    v_add_f32 v44, v44, v48
    v_add_f32 v45, v45, v49
    v_add_f32 v46, v46, v50
    v_add_f32 v47, v47, v51
    v_lshrrev_b32 v55, 4, v1
    v_lshl_add_u32 v54, v55, 3, v54
    v_permlane16_swap_b32 v44, v46
    v_permlane16_swap_b32 v45, v47
    v_add_f32 v44, v44, v46
    v_add_f32 v45, v45, v47
    s_lshl_b32 s36, s20, 8
    v_add_u32 v54, s36, v54
    v_add_f32_dpp v46, v44, v44 row_ror:8 row_mask:0xf bank_mask:0xf
    v_add_f32_dpp v47, v45, v45 row_ror:8 row_mask:0xf bank_mask:0xf
    ds_write_b64 v54, v[46:47]
    s_waitcnt lgkmcnt(0)
    s_barrier
    s_add_u32 s47, s47, 0x9e3779b9
    s_waitcnt vmcnt(5)
    s_xor_b32 s40, s43, 0x100
    buffer_load_dwordx4 a[32:35], v6, s[24:27], s40 offen offset:0 nt
    v_and_b32 v58, 3, v1
    s_waitcnt vmcnt(5)
    s_xor_b32 s40, s43, 0x2100
    buffer_load_dwordx4 a[36:39], v6, s[24:27], s40 offen offset:0 nt
    v_mov_b32 v8, 0
    s_waitcnt vmcnt(5)
    s_xor_b32 s40, s43, 0x40100
    buffer_load_dwordx4 a[40:43], v6, s[24:27], s40 offen offset:0 nt
    v_mov_b32 v9, 0
    s_waitcnt vmcnt(5)
    s_xor_b32 s40, s43, 0x42100
    buffer_load_dwordx4 a[44:47], v6, s[24:27], s40 offen offset:0 nt
    v_mov_b32 v13, 0xffff
    s_waitcnt vmcnt(5)
    s_xor_b32 s40, s43, 0x4100
    buffer_load_dwordx4 a[48:51], v6, s[24:27], s40 offen offset:0 nt
    v_mov_b32 v14, 0xffff0000
    s_waitcnt vmcnt(5)
    s_xor_b32 s40, s43, 0x6100
    buffer_load_dwordx4 a[52:55], v6, s[24:27], s40 offen offset:0 nt
    v_cmp_eq_u32 s[90:91], 0, v58
    s_waitcnt vmcnt(5)
    s_xor_b32 s40, s43, 0x44100
    buffer_load_dwordx4 a[56:59], v6, s[24:27], s40 offen offset:0 nt
    v_cmp_eq_u32 s[92:93], 1, v58
    s_waitcnt vmcnt(5)
    s_xor_b32 s40, s43, 0x46100
    buffer_load_dwordx4 a[60:63], v6, s[24:27], s40 offen offset:0 nt
    v_cmp_eq_u32 s[94:95], 2, v58
    s_waitcnt vmcnt(5)
    s_xor_b32 s40, s43, 0x20000
    buffer_load_dwordx4 a[64:67], v6, s[24:27], s40 offen offset:0 nt
    v_cmp_eq_u32 s[96:97], 3, v58
    s_waitcnt vmcnt(5)
    s_xor_b32 s40, s43, 0x22000
    buffer_load_dwordx4 a[68:71], v6, s[24:27], s40 offen offset:0 nt
    v_cndmask_b32 v8, v8, v13, s[90:91]
    s_waitcnt vmcnt(5)
    s_xor_b32 s40, s43, 0x60000
    buffer_load_dwordx4 a[72:75], v6, s[24:27], s40 offen offset:0 nt
    v_cndmask_b32 v8, v8, v14, s[92:93]
    s_waitcnt vmcnt(5)
    s_xor_b32 s40, s43, 0x62000
    buffer_load_dwordx4 a[76:79], v6, s[24:27], s40 offen offset:0 nt
    v_cndmask_b32 v9, v9, v13, s[94:95]
    s_waitcnt vmcnt(5)
    s_xor_b32 s40, s43, 0x24000
    buffer_load_dwordx4 a[80:83], v6, s[24:27], s40 offen offset:0 nt
    v_cndmask_b32 v9, v9, v14, s[96:97]
    s_waitcnt vmcnt(5)
    s_xor_b32 s40, s43, 0x26000
    buffer_load_dwordx4 a[84:87], v6, s[24:27], s40 offen offset:0 nt
    s_mov_b32 s45, 0x3e0293ee
    s_mov_b32 s44, 1
    s_mov_b64 vcc, 0
    s_waitcnt vmcnt(5)
    s_xor_b32 s40, s43, 0x64000
    buffer_load_dwordx4 a[88:91], v6, s[24:27], s40 offen offset:0 nt
    v_lshrrev_b32 v60, 2, v1
    v_mul_u32_u24 v60, 192, v60
    v_lshl_add_u32 v60, v58, 4, v60
    s_mul_i32 s36, s20, 3072
    s_add_u32 s36, s36, 12288
    v_add_u32 v60, s36, v60
    s_waitcnt vmcnt(5)
    s_xor_b32 s40, s43, 0x66000
    buffer_load_dwordx4 a[92:95], v6, s[24:27], s40 offen offset:0 nt
    s_barrier
    v_bfe_u32 v61, v1, 2, 2
    v_lshlrev_b32 v61, 5, v61
    s_lshl_b32 s36, s20, 3
    v_add_u32 v61, s36, v61
    s_waitcnt vmcnt(5)
    s_xor_b32 s40, s43, 0x20100
    buffer_load_dwordx4 a[96:99], v6, s[24:27], s40 offen offset:0 nt
    v_mov_b32 v62, 0
    v_mov_b32 v63, 1
    s_mov_b32 s41, 0
    s_waitcnt vmcnt(5)
    s_xor_b32 s40, s43, 0x22100
    buffer_load_dwordx4 a[100:103], v6, s[24:27], s40 offen offset:0 nt
    v_and_b32 v59, 15, v1
    v_lshlrev_b32 v59, 4, v59
    v_bfe_u32 v57, v1, 4, 1
    v_lshl_add_u32 v59, v57, 10, v59
    v_lshrrev_b32 v57, 5, v1
    v_lshl_add_u32 v59, v57, 15, v59
    s_waitcnt vmcnt(5)
    s_xor_b32 s40, s43, 0x60100
    buffer_load_dwordx4 a[104:107], v6, s[24:27], s40 offen offset:0 nt
    v_mov_b32 v36, 32
    s_lshl_b32 s36, s20, 2
    v_mov_b32 v38, s36
    s_waitcnt vmcnt(5)
    s_xor_b32 s40, s43, 0x62100
    buffer_load_dwordx4 a[108:111], v6, s[24:27], s40 offen offset:0 nt
    s_waitcnt vmcnt(5)
    s_xor_b32 s40, s43, 0x24100
    buffer_load_dwordx4 a[112:115], v6, s[24:27], s40 offen offset:0 nt
    s_waitcnt vmcnt(7)
    s_xor_b32 s40, s43, 0x26100
    buffer_load_dwordx4 a[116:119], v6, s[24:27], s40 offen offset:0 nt
    s_waitcnt vmcnt(7)
    s_xor_b32 s40, s43, 0x64100
    buffer_load_dwordx4 a[120:123], v6, s[24:27], s40 offen offset:0 nt
    s_waitcnt vmcnt(7)
    s_xor_b32 s40, s43, 0x66100
    buffer_load_dwordx4 a[124:127], v6, s[24:27], s40 offen offset:0 nt
    s_barrier
    ds_read_b128 v[24:27], v2 offset:24832
    ds_write_b32 v38, v36 offset:28944
    s_waitcnt lgkmcnt(0)
    s_branch L_branch
.p2align 12
L_helper:
    v_mov_b32 v14, 0
    v_mov_b32 v15, 0
    v_mov_b32 v8, 1
    v_and_b32 v58, 3, v1
    v_lshlrev_b32 v58, 2, v58
    ds_write_b64 v14, v[14:15] offset:28928
    ds_write_b32 v58, v14 offset:28944
    ds_write_b32 v58, v8 offset:28960
    s_cmp_lg_u32 s2, 0
    s_cbranch_scc1 L_nz
    v_mul_u32_u24 v9, 4352, v1
    s_mov_b32 s36, 2097152
    buffer_store_dword v14, v9, s[32:35], s36 offen sc1
L_nz:
    s_lshl_b32 s36, s3, 13
    s_add_u32 s36, s36, 131072
    s_and_b32 s37, s4, 15
    s_lshl_b32 s37, s37, 9
    s_add_u32 s37, s37, s36
    s_lshl_b32 s39, s5, 16
    s_add_u32 s37, s37, s39
    s_lshl_b32 s36, s62, 13
    s_add_u32 s36, s36, 131072
    s_add_u32 s38, s36, 4096
    v_lshlrev_b32 v6, 3, v1
    v_lshlrev_b32 v7, 2, v1
    s_waitcnt lgkmcnt(0)
    s_add_u32 s47, s47, 0x9e3779b9
    s_getreg_b32 s12, hwreg(HW_REG_XCC_ID, 0, 4)
    s_xor_b32 s12, s12, s47
    v_mov_b32 v17, s47
    v_mov_b32 v19, s12
    s_mov_b32 s13, 1
    s_mov_b32 s14, 8
    s_barrier
    s_mov_b32 exec_hi, 0
    ds_read_b64 v[20:21], v6 offset:0
    ds_read_b64 v[22:23], v6 offset:256
    ds_read_b64 v[24:25], v6 offset:512
    ds_read_b64 v[26:27], v6 offset:768
    s_waitcnt lgkmcnt(0)
    v_add_f32 v20, v20, v22
    v_add_f32 v21, v21, v23
    v_add_f32 v24, v24, v26
    v_add_f32 v25, v25, v27
    v_add_f32 v16, v20, v24
    v_add_f32 v18, v21, v25
    buffer_store_dwordx4 v[16:19], v3, s[32:35], s37 offen
    s_mov_b32 exec_hi, -1
    s_mov_b32 s40, 0
    s_barrier
L_qb:
    s_mov_b32 s39, 200000
L_qg:
    buffer_load_dwordx4 v[20:23], v3, s[32:35], s36 offen offset:0 sc1
    buffer_load_dwordx4 v[24:27], v3, s[32:35], s36 offen offset:1024 sc1
    buffer_load_dwordx4 v[28:31], v3, s[32:35], s36 offen offset:2048 sc1
    buffer_load_dwordx4 v[32:35], v3, s[32:35], s36 offen offset:3072 sc1
    buffer_load_dwordx4 v[36:39], v3, s[32:35], s38 offen offset:0 sc1
    buffer_load_dwordx4 v[40:43], v3, s[32:35], s38 offen offset:1024 sc1
    buffer_load_dwordx4 v[44:47], v3, s[32:35], s38 offen offset:2048 sc1
    buffer_load_dwordx4 v[48:51], v3, s[32:35], s38 offen offset:3072 sc1
    s_sub_u32 s39, s39, 1
    s_cmp_eq_u32 s39, 0
    s_cbranch_scc1 L_qgd
    s_waitcnt vmcnt(0)
    v_xor_b32 v21, v21, v17
    v_xor_b32 v23, v23, v19
    v_xor_b32 v25, v25, v17
    v_xor_b32 v27, v27, v19
    v_xor_b32 v29, v29, v17
    v_xor_b32 v31, v31, v19
    v_xor_b32 v33, v33, v17
    v_xor_b32 v35, v35, v19
    v_xor_b32 v37, v37, v17
    v_xor_b32 v39, v39, v19
    v_xor_b32 v41, v41, v17
    v_xor_b32 v43, v43, v19
    v_xor_b32 v45, v45, v17
    v_xor_b32 v47, v47, v19
    v_xor_b32 v49, v49, v17
    v_xor_b32 v51, v51, v19
    v_or3_b32 v12, v21, v25, v29
    v_or3_b32 v13, v23, v27, v31
    v_or3_b32 v12, v12, v33, v37
    v_or3_b32 v13, v13, v35, v39
    v_or3_b32 v12, v12, v41, v45
    v_or3_b32 v13, v13, v43, v47
    v_or_b32 v13, v13, v51
    v_lshrrev_b32 v15, 4, v13
    v_or3_b32 v12, v12, v49, v15
    v_cmp_ne_u32 vcc, 0, v12
    s_and_b64 exec, exec, vcc
    s_cbranch_execz L_qgd
    s_sub_u32 s14, s14, 1
    s_cmp_lg_u32 s14, 0
    s_cbranch_scc1 L_qs
    s_mov_b64 s[60:61], exec
    s_mov_b32 exec_lo, -1
    s_mov_b32 exec_hi, 0
    buffer_store_dwordx4 v[16:19], v3, s[32:35], s37 offen sc1
    s_mov_b64 exec, s[60:61]
L_qs:
    s_sleep 2
    s_branch L_qg
L_qgd:
    s_mov_b64 exec, -1
    s_waitcnt vmcnt(0)
    v_cmp_ne_u32 vcc, 0, v13
    s_cbranch_vccz L_ql
    s_mov_b32 s13, 2
    s_mov_b32 exec_hi, 0
    buffer_store_dwordx4 v[16:19], v3, s[32:35], s37 offen sc1
    s_mov_b32 exec_hi, -1
L_ql:
    v_add_f32 v20, v20, v36
    v_add_f32 v22, v22, v38
    v_cvt_pk_bf16_f32 v8, v20, v22
    v_add_f32 v24, v24, v40
    v_add_f32 v26, v26, v42
    v_cvt_pk_bf16_f32 v9, v24, v26
    v_add_f32 v28, v28, v44
    v_add_f32 v30, v30, v46
    v_cvt_pk_bf16_f32 v10, v28, v30
    v_add_f32 v32, v32, v48
    v_add_f32 v34, v34, v50
    v_cvt_pk_bf16_f32 v11, v32, v34
    ds_write_b32 v7, v8 offset:24832
    ds_write_b32 v7, v9 offset:25088
    ds_write_b32 v7, v10 offset:25344
    ds_write_b32 v7, v11 offset:25600
    s_waitcnt lgkmcnt(0)
    s_cmp_lg_u32 s40, 0
    s_cbranch_scc1 L_q2
    s_barrier
    s_mov_b32 s40, 1
    s_add_u32 s36, s36, 65536
    s_add_u32 s38, s38, 65536
    v_add_u32 v7, 1024, v7
    s_branch L_qb
L_q2:
    s_mov_b32 s10, s13
    v_mov_b32 v15, s13
    ds_write_b32 v14, v15 offset:28928
    s_mul_i32 s28, s62, 98304
    s_mul_i32 s29, s63, 768
    s_add_u32 s28, s28, s29
    s_add_u32 s28, s28, 524288
    s_add_u32 s29, s28, 24576
    s_add_u32 s30, s28, 49152
    s_add_u32 s31, s28, 73728
    s_mov_b64 exec, 0
    s_branch L_w0
.p2align 6
L_branch:
    s_mov_b32 s37, 4
    .p2align 3
L_kloop:
    s_add_u32 s46, s46, 1
    s_bfe_u32 s43, s46, 0x10000
    s_lshl_b32 s43, s43, 19
    s_bfe_u32 s6, s46, 0x10001
    s_lshl_b32 s6, s6, 12
    s_or_b32 s43, s43, s6
    s_xor_b32 s43, s43, s21
    s_cmp_lg_u32 s37, 1
    s_cbranch_scc1 L_k1
    s_cmp_eq_u32 s41, 0
    s_cselect_b32 s24, s82, s86
    s_cselect_b32 s25, s83, s87
    v_mov_b32 v6, v59
L_k1:
    v_mfma_f32_16x16x32_bf16 v[40:43], a[0:3], v[24:27], 0
    v_add_f32_dpp v13, v51, v50 quad_perm:[3,3,3,3] row_mask:0xf bank_mask:0xf
    v_add_f32_dpp v14, v49, v48 quad_perm:[1,1,1,1] row_mask:0xf bank_mask:0xf
    s_cmp_lg_u32 s44, 0
    s_cbranch_scc1 L_ka0
    s_waitcnt vmcnt(3)
L_ka0:
    s_cbranch_vccnz L_kb0
    s_waitcnt vmcnt(4)
L_kb0:
    s_waitcnt vmcnt(5)
    buffer_load_dwordx4 a[0:3], v6, s[24:27], s43 offen offset:0 nt
    ds_read_b32 v37, v38 offset:28960
    v_add_f32_dpp v13, v14, v13 quad_perm:[0,0,0,0] row_mask:0xf bank_mask:0xf
    v_cndmask_b32 v95, v95, v13, s[94:95]
    v_mov_b32 v64, v72
    v_mov_b32 v72, v80
    v_mfma_f32_16x16x32_bf16 v[44:47], a[4:7], v[24:27], 0
    v_add_f32_dpp v13, v54, v55 quad_perm:[2,2,2,2] row_mask:0xf bank_mask:0xf
    v_add_f32_dpp v14, v52, v53 quad_perm:[0,0,0,0] row_mask:0xf bank_mask:0xf
    s_cbranch_vccnz L_kb1
    s_waitcnt vmcnt(4)
L_kb1:
    s_waitcnt vmcnt(5)
    s_xor_b32 s40, s43, 0x2000
    buffer_load_dwordx4 a[4:7], v6, s[24:27], s40 offen offset:0 nt
    s_waitcnt lgkmcnt(0)
    v_cmp_eq_u32 vcc, 2, v37
    v_readfirstlane_b32 s44, v37
    v_add_f32_dpp v13, v14, v13 quad_perm:[1,1,1,1] row_mask:0xf bank_mask:0xf
    v_cndmask_b32 v95, v95, v13, s[96:97]
    v_mov_b32 v80, v88
    v_mfma_f32_16x16x32_bf16 v[48:51], a[8:11], v[24:27], 0
    v_add_f32_dpp v13, v41, v40 quad_perm:[1,1,1,1] row_mask:0xf bank_mask:0xf
    v_add_f32_dpp v14, v43, v42 quad_perm:[3,3,3,3] row_mask:0xf bank_mask:0xf
    s_cbranch_vccnz L_kb2
    s_waitcnt vmcnt(4)
L_kb2:
    s_waitcnt vmcnt(5)
    s_xor_b32 s40, s43, 0x40000
    buffer_load_dwordx4 a[8:11], v6, s[24:27], s40 offen offset:0 nt
    v_add_f32_dpp v13, v14, v13 quad_perm:[2,2,2,2] row_mask:0xf bank_mask:0xf
    v_cndmask_b32 v88, v88, v13, s[90:91]
    v_mfma_f32_16x16x32_bf16 v[52:55], a[12:15], v[24:27], 0
    v_add_f32_dpp v13, v44, v45 quad_perm:[0,0,0,0] row_mask:0xf bank_mask:0xf
    v_add_f32_dpp v14, v46, v47 quad_perm:[2,2,2,2] row_mask:0xf bank_mask:0xf
    s_cbranch_vccnz L_kb3
    s_waitcnt vmcnt(4)
L_kb3:
    s_waitcnt vmcnt(5)
    s_xor_b32 s40, s43, 0x42000
    buffer_load_dwordx4 a[12:15], v6, s[24:27], s40 offen offset:0 nt
    v_add_u32 v36, 4, v36
    ds_write_b32 v38, v36 offset:28944
    v_add_f32_dpp v13, v14, v13 quad_perm:[3,3,3,3] row_mask:0xf bank_mask:0xf
    v_cndmask_b32 v88, v88, v13, s[92:93]
    v_mov_b32 v65, v73
    v_mfma_f32_16x16x32_bf16 v[40:43], a[16:19], v[24:27], 0
    v_add_f32_dpp v13, v51, v50 quad_perm:[3,3,3,3] row_mask:0xf bank_mask:0xf
    v_add_f32_dpp v14, v49, v48 quad_perm:[1,1,1,1] row_mask:0xf bank_mask:0xf
    s_cmp_lg_u32 s44, 0
    s_cbranch_scc1 L_ka4
    s_waitcnt vmcnt(3)
L_ka4:
    s_cbranch_vccnz L_kb4
    s_waitcnt vmcnt(4)
L_kb4:
    s_waitcnt vmcnt(5)
    s_xor_b32 s40, s43, 0x4000
    buffer_load_dwordx4 a[16:19], v6, s[24:27], s40 offen offset:0 nt
    v_add_f32_dpp v13, v14, v13 quad_perm:[0,0,0,0] row_mask:0xf bank_mask:0xf
    v_cndmask_b32 v88, v88, v13, s[94:95]
    v_mov_b32 v73, v81
    v_mfma_f32_16x16x32_bf16 v[44:47], a[20:23], v[24:27], 0
    v_add_f32_dpp v13, v54, v55 quad_perm:[2,2,2,2] row_mask:0xf bank_mask:0xf
    v_add_f32_dpp v14, v52, v53 quad_perm:[0,0,0,0] row_mask:0xf bank_mask:0xf
    s_cbranch_vccnz L_kb5
    s_waitcnt vmcnt(4)
L_kb5:
    s_waitcnt vmcnt(5)
    s_xor_b32 s40, s43, 0x6000
    buffer_load_dwordx4 a[20:23], v6, s[24:27], s40 offen offset:0 nt
    v_add_f32_dpp v13, v14, v13 quad_perm:[1,1,1,1] row_mask:0xf bank_mask:0xf
    v_cndmask_b32 v88, v88, v13, s[96:97]
    v_mov_b32 v81, v89
    v_mfma_f32_16x16x32_bf16 v[48:51], a[24:27], v[24:27], 0
    v_add_f32_dpp v13, v41, v40 quad_perm:[1,1,1,1] row_mask:0xf bank_mask:0xf
    v_add_f32_dpp v14, v43, v42 quad_perm:[3,3,3,3] row_mask:0xf bank_mask:0xf
    s_cbranch_vccnz L_kb6
    s_waitcnt vmcnt(4)
L_kb6:
    s_waitcnt vmcnt(5)
    s_xor_b32 s40, s43, 0x44000
    buffer_load_dwordx4 a[24:27], v6, s[24:27], s40 offen offset:0 nt
    v_add_f32_dpp v13, v14, v13 quad_perm:[2,2,2,2] row_mask:0xf bank_mask:0xf
    v_cndmask_b32 v89, v89, v13, s[90:91]
    v_mfma_f32_16x16x32_bf16 v[52:55], a[28:31], v[24:27], 0
    v_add_f32_dpp v13, v44, v45 quad_perm:[0,0,0,0] row_mask:0xf bank_mask:0xf
    v_add_f32_dpp v14, v46, v47 quad_perm:[2,2,2,2] row_mask:0xf bank_mask:0xf
    s_cbranch_vccnz L_kb7
    s_waitcnt vmcnt(4)
L_kb7:
    s_waitcnt vmcnt(5)
    s_xor_b32 s40, s43, 0x46000
    buffer_load_dwordx4 a[28:31], v6, s[24:27], s40 offen offset:0 nt
    v_add_u32 v36, 4, v36
    ds_write_b32 v38, v36 offset:28944
    v_add_f32_dpp v13, v14, v13 quad_perm:[3,3,3,3] row_mask:0xf bank_mask:0xf
    v_cndmask_b32 v89, v89, v13, s[92:93]
    v_mov_b32 v66, v74
    v_mfma_f32_16x16x32_bf16 v[40:43], a[32:35], v[24:27], 0
    v_add_f32_dpp v13, v51, v50 quad_perm:[3,3,3,3] row_mask:0xf bank_mask:0xf
    v_add_f32_dpp v14, v49, v48 quad_perm:[1,1,1,1] row_mask:0xf bank_mask:0xf
    s_cmp_lg_u32 s44, 0
    s_cbranch_scc1 L_ka8
    s_waitcnt vmcnt(3)
L_ka8:
    s_cbranch_vccnz L_kb8
    s_waitcnt vmcnt(4)
L_kb8:
    s_waitcnt vmcnt(5)
    s_xor_b32 s40, s43, 0x100
    buffer_load_dwordx4 a[32:35], v6, s[24:27], s40 offen offset:0 nt
    ds_read_b32 v37, v38 offset:28960
    v_add_f32_dpp v13, v14, v13 quad_perm:[0,0,0,0] row_mask:0xf bank_mask:0xf
    v_cndmask_b32 v89, v89, v13, s[94:95]
    v_mov_b32 v74, v82
    v_mfma_f32_16x16x32_bf16 v[44:47], a[36:39], v[24:27], 0
    v_add_f32_dpp v13, v54, v55 quad_perm:[2,2,2,2] row_mask:0xf bank_mask:0xf
    v_add_f32_dpp v14, v52, v53 quad_perm:[0,0,0,0] row_mask:0xf bank_mask:0xf
    s_cbranch_vccnz L_kb9
    s_waitcnt vmcnt(4)
L_kb9:
    s_waitcnt vmcnt(5)
    s_xor_b32 s40, s43, 0x2100
    buffer_load_dwordx4 a[36:39], v6, s[24:27], s40 offen offset:0 nt
    s_waitcnt lgkmcnt(0)
    v_cmp_eq_u32 vcc, 2, v37
    v_readfirstlane_b32 s44, v37
    v_add_f32_dpp v13, v14, v13 quad_perm:[1,1,1,1] row_mask:0xf bank_mask:0xf
    v_cndmask_b32 v89, v89, v13, s[96:97]
    v_mov_b32 v82, v90
    v_mfma_f32_16x16x32_bf16 v[48:51], a[40:43], v[24:27], 0
    v_add_f32_dpp v13, v41, v40 quad_perm:[1,1,1,1] row_mask:0xf bank_mask:0xf
    v_add_f32_dpp v14, v43, v42 quad_perm:[3,3,3,3] row_mask:0xf bank_mask:0xf
    s_cbranch_vccnz L_kb10
    s_waitcnt vmcnt(4)
L_kb10:
    s_waitcnt vmcnt(5)
    s_xor_b32 s40, s43, 0x40100
    buffer_load_dwordx4 a[40:43], v6, s[24:27], s40 offen offset:0 nt
    v_add_f32_dpp v13, v14, v13 quad_perm:[2,2,2,2] row_mask:0xf bank_mask:0xf
    v_cndmask_b32 v90, v90, v13, s[90:91]
    v_mfma_f32_16x16x32_bf16 v[52:55], a[44:47], v[24:27], 0
    v_add_f32_dpp v13, v44, v45 quad_perm:[0,0,0,0] row_mask:0xf bank_mask:0xf
    v_add_f32_dpp v14, v46, v47 quad_perm:[2,2,2,2] row_mask:0xf bank_mask:0xf
    s_cbranch_vccnz L_kb11
    s_waitcnt vmcnt(4)
L_kb11:
    s_waitcnt vmcnt(5)
    s_xor_b32 s40, s43, 0x42100
    buffer_load_dwordx4 a[44:47], v6, s[24:27], s40 offen offset:0 nt
    v_add_u32 v36, 4, v36
    ds_write_b32 v38, v36 offset:28944
    v_add_f32_dpp v13, v14, v13 quad_perm:[3,3,3,3] row_mask:0xf bank_mask:0xf
    v_cndmask_b32 v90, v90, v13, s[92:93]
    v_mov_b32 v67, v75
    v_mfma_f32_16x16x32_bf16 v[40:43], a[48:51], v[24:27], 0
    v_add_f32_dpp v13, v51, v50 quad_perm:[3,3,3,3] row_mask:0xf bank_mask:0xf
    v_add_f32_dpp v14, v49, v48 quad_perm:[1,1,1,1] row_mask:0xf bank_mask:0xf
    s_cmp_lg_u32 s44, 0
    s_cbranch_scc1 L_ka12
    s_waitcnt vmcnt(3)
L_ka12:
    s_cbranch_vccnz L_kb12
    s_waitcnt vmcnt(4)
L_kb12:
    s_waitcnt vmcnt(5)
    s_xor_b32 s40, s43, 0x4100
    buffer_load_dwordx4 a[48:51], v6, s[24:27], s40 offen offset:0 nt
    v_add_f32_dpp v13, v14, v13 quad_perm:[0,0,0,0] row_mask:0xf bank_mask:0xf
    v_cndmask_b32 v90, v90, v13, s[94:95]
    v_mov_b32 v75, v83
    v_mfma_f32_16x16x32_bf16 v[44:47], a[52:55], v[24:27], 0
    v_add_f32_dpp v13, v54, v55 quad_perm:[2,2,2,2] row_mask:0xf bank_mask:0xf
    v_add_f32_dpp v14, v52, v53 quad_perm:[0,0,0,0] row_mask:0xf bank_mask:0xf
    s_cbranch_vccnz L_kb13
    s_waitcnt vmcnt(4)
L_kb13:
    s_waitcnt vmcnt(5)
    s_xor_b32 s40, s43, 0x6100
    buffer_load_dwordx4 a[52:55], v6, s[24:27], s40 offen offset:0 nt
    v_add_f32_dpp v13, v14, v13 quad_perm:[1,1,1,1] row_mask:0xf bank_mask:0xf
    v_cndmask_b32 v90, v90, v13, s[96:97]
    v_mov_b32 v83, v91
    v_mfma_f32_16x16x32_bf16 v[48:51], a[56:59], v[24:27], 0
    v_add_f32_dpp v13, v41, v40 quad_perm:[1,1,1,1] row_mask:0xf bank_mask:0xf
    v_add_f32_dpp v14, v43, v42 quad_perm:[3,3,3,3] row_mask:0xf bank_mask:0xf
    s_cbranch_vccnz L_kb14
    s_waitcnt vmcnt(4)
L_kb14:
    s_waitcnt vmcnt(5)
    s_xor_b32 s40, s43, 0x44100
    buffer_load_dwordx4 a[56:59], v6, s[24:27], s40 offen offset:0 nt
    v_add_f32_dpp v13, v14, v13 quad_perm:[2,2,2,2] row_mask:0xf bank_mask:0xf
    v_cndmask_b32 v91, v91, v13, s[90:91]
    v_mfma_f32_16x16x32_bf16 v[52:55], a[60:63], v[24:27], 0
    v_add_f32_dpp v13, v44, v45 quad_perm:[0,0,0,0] row_mask:0xf bank_mask:0xf
    v_add_f32_dpp v14, v46, v47 quad_perm:[2,2,2,2] row_mask:0xf bank_mask:0xf
    s_cbranch_vccnz L_kb15
    s_waitcnt vmcnt(4)
L_kb15:
    s_waitcnt vmcnt(5)
    s_xor_b32 s40, s43, 0x46100
    buffer_load_dwordx4 a[60:63], v6, s[24:27], s40 offen offset:0 nt
    v_add_u32 v36, 4, v36
    ds_write_b32 v38, v36 offset:28944
    v_add_f32_dpp v13, v14, v13 quad_perm:[3,3,3,3] row_mask:0xf bank_mask:0xf
    v_cndmask_b32 v91, v91, v13, s[92:93]
    v_mov_b32 v68, v76
    v_mfma_f32_16x16x32_bf16 v[40:43], a[64:67], v[24:27], 0
    v_add_f32_dpp v13, v51, v50 quad_perm:[3,3,3,3] row_mask:0xf bank_mask:0xf
    v_add_f32_dpp v14, v49, v48 quad_perm:[1,1,1,1] row_mask:0xf bank_mask:0xf
    s_cmp_lg_u32 s44, 0
    s_cbranch_scc1 L_ka16
    s_waitcnt vmcnt(3)
L_ka16:
    s_cbranch_vccnz L_kb16
    s_waitcnt vmcnt(4)
L_kb16:
    s_waitcnt vmcnt(5)
    s_xor_b32 s40, s43, 0x20000
    buffer_load_dwordx4 a[64:67], v6, s[24:27], s40 offen offset:0 nt
    ds_read_b32 v37, v38 offset:28960
    v_add_f32_dpp v13, v14, v13 quad_perm:[0,0,0,0] row_mask:0xf bank_mask:0xf
    v_cndmask_b32 v91, v91, v13, s[94:95]
    v_mov_b32 v76, v84
    v_mfma_f32_16x16x32_bf16 v[44:47], a[68:71], v[24:27], 0
    v_add_f32_dpp v13, v54, v55 quad_perm:[2,2,2,2] row_mask:0xf bank_mask:0xf
    v_add_f32_dpp v14, v52, v53 quad_perm:[0,0,0,0] row_mask:0xf bank_mask:0xf
    s_cbranch_vccnz L_kb17
    s_waitcnt vmcnt(4)
L_kb17:
    s_waitcnt vmcnt(5)
    s_xor_b32 s40, s43, 0x22000
    buffer_load_dwordx4 a[68:71], v6, s[24:27], s40 offen offset:0 nt
    s_waitcnt lgkmcnt(0)
    v_cmp_eq_u32 vcc, 2, v37
    v_readfirstlane_b32 s44, v37
    v_add_f32_dpp v13, v14, v13 quad_perm:[1,1,1,1] row_mask:0xf bank_mask:0xf
    v_cndmask_b32 v91, v91, v13, s[96:97]
    v_mov_b32 v84, v92
    v_mfma_f32_16x16x32_bf16 v[48:51], a[72:75], v[24:27], 0
    v_add_f32_dpp v13, v41, v40 quad_perm:[1,1,1,1] row_mask:0xf bank_mask:0xf
    v_add_f32_dpp v14, v43, v42 quad_perm:[3,3,3,3] row_mask:0xf bank_mask:0xf
    s_cbranch_vccnz L_kb18
    s_waitcnt vmcnt(4)
L_kb18:
    s_waitcnt vmcnt(5)
    s_xor_b32 s40, s43, 0x60000
    buffer_load_dwordx4 a[72:75], v6, s[24:27], s40 offen offset:0 nt
    v_add_f32_dpp v13, v14, v13 quad_perm:[2,2,2,2] row_mask:0xf bank_mask:0xf
    v_cndmask_b32 v92, v92, v13, s[90:91]
    v_mfma_f32_16x16x32_bf16 v[52:55], a[76:79], v[24:27], 0
    v_add_f32_dpp v13, v44, v45 quad_perm:[0,0,0,0] row_mask:0xf bank_mask:0xf
    v_add_f32_dpp v14, v46, v47 quad_perm:[2,2,2,2] row_mask:0xf bank_mask:0xf
    s_cbranch_vccnz L_kb19
    s_waitcnt vmcnt(4)
L_kb19:
    s_waitcnt vmcnt(5)
    s_xor_b32 s40, s43, 0x62000
    buffer_load_dwordx4 a[76:79], v6, s[24:27], s40 offen offset:0 nt
    v_add_u32 v36, 4, v36
    ds_write_b32 v38, v36 offset:28944
    v_add_f32_dpp v13, v14, v13 quad_perm:[3,3,3,3] row_mask:0xf bank_mask:0xf
    v_cndmask_b32 v92, v92, v13, s[92:93]
    v_mov_b32 v69, v77
    v_mfma_f32_16x16x32_bf16 v[40:43], a[80:83], v[24:27], 0
    v_add_f32_dpp v13, v51, v50 quad_perm:[3,3,3,3] row_mask:0xf bank_mask:0xf
    v_add_f32_dpp v14, v49, v48 quad_perm:[1,1,1,1] row_mask:0xf bank_mask:0xf
    s_cmp_lg_u32 s44, 0
    s_cbranch_scc1 L_ka20
    s_waitcnt vmcnt(3)
L_ka20:
    s_cbranch_vccnz L_kb20
    s_waitcnt vmcnt(4)
L_kb20:
    s_waitcnt vmcnt(5)
    s_xor_b32 s40, s43, 0x24000
    buffer_load_dwordx4 a[80:83], v6, s[24:27], s40 offen offset:0 nt
    v_add_f32_dpp v13, v14, v13 quad_perm:[0,0,0,0] row_mask:0xf bank_mask:0xf
    v_cndmask_b32 v92, v92, v13, s[94:95]
    v_mov_b32 v77, v85
    v_mfma_f32_16x16x32_bf16 v[44:47], a[84:87], v[24:27], 0
    v_add_f32_dpp v13, v54, v55 quad_perm:[2,2,2,2] row_mask:0xf bank_mask:0xf
    v_add_f32_dpp v14, v52, v53 quad_perm:[0,0,0,0] row_mask:0xf bank_mask:0xf
    s_cbranch_vccnz L_kb21
    s_waitcnt vmcnt(4)
L_kb21:
    s_waitcnt vmcnt(5)
    s_xor_b32 s40, s43, 0x26000
    buffer_load_dwordx4 a[84:87], v6, s[24:27], s40 offen offset:0 nt
    v_add_f32_dpp v13, v14, v13 quad_perm:[1,1,1,1] row_mask:0xf bank_mask:0xf
    v_cndmask_b32 v92, v92, v13, s[96:97]
    v_mov_b32 v85, v93
    v_mfma_f32_16x16x32_bf16 v[48:51], a[88:91], v[24:27], 0
    v_add_f32_dpp v13, v41, v40 quad_perm:[1,1,1,1] row_mask:0xf bank_mask:0xf
    v_add_f32_dpp v14, v43, v42 quad_perm:[3,3,3,3] row_mask:0xf bank_mask:0xf
    s_cbranch_vccnz L_kb22
    s_waitcnt vmcnt(4)
L_kb22:
    s_waitcnt vmcnt(5)
    s_xor_b32 s40, s43, 0x64000
    buffer_load_dwordx4 a[88:91], v6, s[24:27], s40 offen offset:0 nt
    v_add_f32_dpp v13, v14, v13 quad_perm:[2,2,2,2] row_mask:0xf bank_mask:0xf
    v_cndmask_b32 v93, v93, v13, s[90:91]
    v_mfma_f32_16x16x32_bf16 v[52:55], a[92:95], v[24:27], 0
    v_add_f32_dpp v13, v44, v45 quad_perm:[0,0,0,0] row_mask:0xf bank_mask:0xf
    v_add_f32_dpp v14, v46, v47 quad_perm:[2,2,2,2] row_mask:0xf bank_mask:0xf
    s_cbranch_vccnz L_kb23
    s_waitcnt vmcnt(4)
L_kb23:
    s_waitcnt vmcnt(5)
    s_xor_b32 s40, s43, 0x66000
    buffer_load_dwordx4 a[92:95], v6, s[24:27], s40 offen offset:0 nt
    v_add_u32 v36, 4, v36
    ds_write_b32 v38, v36 offset:28944
    v_add_f32_dpp v13, v14, v13 quad_perm:[3,3,3,3] row_mask:0xf bank_mask:0xf
    v_cndmask_b32 v93, v93, v13, s[92:93]
    v_mov_b32 v70, v78
    v_mfma_f32_16x16x32_bf16 v[40:43], a[96:99], v[24:27], 0
    v_add_f32_dpp v13, v51, v50 quad_perm:[3,3,3,3] row_mask:0xf bank_mask:0xf
    v_add_f32_dpp v14, v49, v48 quad_perm:[1,1,1,1] row_mask:0xf bank_mask:0xf
    s_cmp_lg_u32 s44, 0
    s_cbranch_scc1 L_ka24
    s_waitcnt vmcnt(3)
L_ka24:
    s_cbranch_vccnz L_kb24
    s_waitcnt vmcnt(4)
L_kb24:
    s_waitcnt vmcnt(5)
    s_xor_b32 s40, s43, 0x20100
    buffer_load_dwordx4 a[96:99], v6, s[24:27], s40 offen offset:0 nt
    ds_read_b32 v37, v38 offset:28960
    v_add_f32_dpp v13, v14, v13 quad_perm:[0,0,0,0] row_mask:0xf bank_mask:0xf
    v_cndmask_b32 v93, v93, v13, s[94:95]
    v_mov_b32 v78, v86
    v_mfma_f32_16x16x32_bf16 v[44:47], a[100:103], v[24:27], 0
    v_add_f32_dpp v13, v54, v55 quad_perm:[2,2,2,2] row_mask:0xf bank_mask:0xf
    v_add_f32_dpp v14, v52, v53 quad_perm:[0,0,0,0] row_mask:0xf bank_mask:0xf
    s_cbranch_vccnz L_kb25
    s_waitcnt vmcnt(4)
L_kb25:
    s_waitcnt vmcnt(5)
    s_xor_b32 s40, s43, 0x22100
    buffer_load_dwordx4 a[100:103], v6, s[24:27], s40 offen offset:0 nt
    s_waitcnt lgkmcnt(0)
    v_cmp_eq_u32 vcc, 2, v37
    v_readfirstlane_b32 s44, v37
    v_add_f32_dpp v13, v14, v13 quad_perm:[1,1,1,1] row_mask:0xf bank_mask:0xf
    v_cndmask_b32 v93, v93, v13, s[96:97]
    v_mov_b32 v86, v94
    v_mfma_f32_16x16x32_bf16 v[48:51], a[104:107], v[24:27], 0
    v_add_f32_dpp v13, v41, v40 quad_perm:[1,1,1,1] row_mask:0xf bank_mask:0xf
    v_add_f32_dpp v14, v43, v42 quad_perm:[3,3,3,3] row_mask:0xf bank_mask:0xf
    s_cbranch_vccnz L_kb26
    s_waitcnt vmcnt(4)
L_kb26:
    s_waitcnt vmcnt(5)
    s_xor_b32 s40, s43, 0x60100
    buffer_load_dwordx4 a[104:107], v6, s[24:27], s40 offen offset:0 nt
    v_add_f32_dpp v13, v14, v13 quad_perm:[2,2,2,2] row_mask:0xf bank_mask:0xf
    v_cndmask_b32 v94, v94, v13, s[90:91]
    v_mfma_f32_16x16x32_bf16 v[52:55], a[108:111], v[24:27], 0
    v_add_f32_dpp v13, v44, v45 quad_perm:[0,0,0,0] row_mask:0xf bank_mask:0xf
    v_add_f32_dpp v14, v46, v47 quad_perm:[2,2,2,2] row_mask:0xf bank_mask:0xf
    s_cbranch_vccnz L_kb27
    s_waitcnt vmcnt(4)
L_kb27:
    s_waitcnt vmcnt(5)
    s_xor_b32 s40, s43, 0x62100
    buffer_load_dwordx4 a[108:111], v6, s[24:27], s40 offen offset:0 nt
    v_add_u32 v36, 4, v36
    ds_write_b32 v38, v36 offset:28944
    v_add_f32_dpp v13, v14, v13 quad_perm:[3,3,3,3] row_mask:0xf bank_mask:0xf
    v_cndmask_b32 v94, v94, v13, s[92:93]
    v_mov_b32 v71, v79
    v_mfma_f32_16x16x32_bf16 v[40:43], a[112:115], v[24:27], 0
    v_add_f32_dpp v13, v51, v50 quad_perm:[3,3,3,3] row_mask:0xf bank_mask:0xf
    v_add_f32_dpp v14, v49, v48 quad_perm:[1,1,1,1] row_mask:0xf bank_mask:0xf
    s_cmp_lg_u32 s44, 0
    s_cbranch_scc1 L_ka28
    s_waitcnt vmcnt(3)
L_ka28:
    s_cbranch_vccnz L_kb28
    s_waitcnt vmcnt(4)
L_kb28:
    s_waitcnt vmcnt(5)
    s_xor_b32 s40, s43, 0x24100
    buffer_load_dwordx4 a[112:115], v6, s[24:27], s40 offen offset:0 nt
    v_add_f32_dpp v13, v14, v13 quad_perm:[0,0,0,0] row_mask:0xf bank_mask:0xf
    v_cndmask_b32 v94, v94, v13, s[94:95]
    v_mov_b32 v79, v87
    v_mfma_f32_16x16x32_bf16 v[44:47], a[116:119], v[24:27], 0
    v_add_f32_dpp v13, v54, v55 quad_perm:[2,2,2,2] row_mask:0xf bank_mask:0xf
    v_add_f32_dpp v14, v52, v53 quad_perm:[0,0,0,0] row_mask:0xf bank_mask:0xf
    s_cbranch_vccnz L_kb29
    s_waitcnt vmcnt(4)
L_kb29:
    s_waitcnt vmcnt(5)
    s_xor_b32 s40, s43, 0x26100
    buffer_load_dwordx4 a[116:119], v6, s[24:27], s40 offen offset:0 nt
    v_add_f32_dpp v13, v14, v13 quad_perm:[1,1,1,1] row_mask:0xf bank_mask:0xf
    v_cndmask_b32 v94, v94, v13, s[96:97]
    v_mov_b32 v87, v95
    v_mfma_f32_16x16x32_bf16 v[48:51], a[120:123], v[24:27], 0
    v_add_f32_dpp v13, v41, v40 quad_perm:[1,1,1,1] row_mask:0xf bank_mask:0xf
    v_add_f32_dpp v14, v43, v42 quad_perm:[3,3,3,3] row_mask:0xf bank_mask:0xf
    s_cbranch_vccnz L_kb30
    s_waitcnt vmcnt(4)
L_kb30:
    s_waitcnt vmcnt(5)
    s_xor_b32 s40, s43, 0x64100
    buffer_load_dwordx4 a[120:123], v6, s[24:27], s40 offen offset:0 nt
    v_add_f32_dpp v13, v14, v13 quad_perm:[2,2,2,2] row_mask:0xf bank_mask:0xf
    v_cndmask_b32 v95, v95, v13, s[90:91]
    v_mfma_f32_16x16x32_bf16 v[52:55], a[124:127], v[24:27], 0
    v_add_f32_dpp v13, v44, v45 quad_perm:[0,0,0,0] row_mask:0xf bank_mask:0xf
    v_add_f32_dpp v14, v46, v47 quad_perm:[2,2,2,2] row_mask:0xf bank_mask:0xf
    s_cbranch_vccnz L_kb31
    s_waitcnt vmcnt(4)
L_kb31:
    s_waitcnt vmcnt(5)
    s_xor_b32 s40, s43, 0x66100
    buffer_load_dwordx4 a[124:127], v6, s[24:27], s40 offen offset:0 nt
    v_add_u32 v36, 4, v36
    ds_write_b32 v38, v36 offset:28944
    v_add_f32_dpp v13, v14, v13 quad_perm:[3,3,3,3] row_mask:0xf bank_mask:0xf
    v_cndmask_b32 v95, v95, v13, s[92:93]
    s_sub_u32 s37, s37, 1
    s_cmp_lg_u32 s37, 0
    s_cbranch_scc1 L_kloop
L_w0:
    s_cbranch_execz L_w1
    v_add_f32_dpp v13, v51, v50 quad_perm:[3,3,3,3] row_mask:0xf bank_mask:0xf
    v_add_f32_dpp v14, v49, v48 quad_perm:[1,1,1,1] row_mask:0xf bank_mask:0xf
    v_mov_b32 v16, 0
    v_mov_b32 v17, 0
    v_mov_b32 v18, 0
    v_mov_b32 v19, 0
    v_mov_b32 v20, 0
    v_mov_b32 v21, 0
    v_mov_b32 v22, 0
    v_mov_b32 v23, 0
    v_add_f32_dpp v13, v14, v13 quad_perm:[0,0,0,0] row_mask:0xf bank_mask:0xf
    v_cndmask_b32 v95, v95, v13, s[94:95]
    v_add_f32_dpp v13, v54, v55 quad_perm:[2,2,2,2] row_mask:0xf bank_mask:0xf
    v_add_f32_dpp v14, v52, v53 quad_perm:[0,0,0,0] row_mask:0xf bank_mask:0xf
    v_max3_f32 v10, v64, v65, v66
    v_max3_f32 v10, v10, v67, v68
    v_add_f32_dpp v13, v14, v13 quad_perm:[1,1,1,1] row_mask:0xf bank_mask:0xf
    v_cndmask_b32 v95, v95, v13, s[96:97]
L_w1:
    s_cbranch_execz L_w2
    v_max3_f32 v10, v10, v69, v70
    v_max3_f32 v10, v10, v71, v72
    v_max3_f32 v10, v10, v73, v74
    v_max3_f32 v10, v10, v75, v76
    v_max3_f32 v10, v10, v77, v78
    v_max3_f32 v10, v10, v79, v80
    v_max3_f32 v10, v10, v81, v82
    v_max3_f32 v10, v10, v83, v84
    v_max3_f32 v10, v10, v85, v86
    v_max3_f32 v10, v10, v87, v88
    v_max3_f32 v10, v10, v89, v90
    v_max3_f32 v10, v10, v91, v92
    v_max3_f32 v10, v10, v93, v94
    v_max_f32 v10, v10, v95
    v_mov_b32 v11, 0
    s_nop 0
    v_max_f32_dpp v10, v10, v10 quad_perm:[1,0,3,2] row_mask:0xf bank_mask:0xf
    s_nop 1
    v_max_f32_dpp v10, v10, v10 quad_perm:[2,3,0,1] row_mask:0xf bank_mask:0xf
    v_mov_b32 v12, v10
    s_nop 1
    v_permlane16_swap_b32 v12, v10
    v_max_f32 v10, v10, v12
    v_mov_b32 v12, v10
    s_nop 1
    v_permlane32_swap_b32 v12, v10
    v_max_f32 v10, v10, v12
L_w2:
    s_cbranch_execz L_w3
    v_mul_f32 v10, s45, v10
    v_fma_f32 v12, v64, s45, -v10
    v_exp_f32 v12, v12
    v_mov_b32 v64, v72
    v_cvt_pk_bf16_f32 v28, v12, v12
    v_mov_b32 v72, v80
    v_add_f32 v11, v11, v12
    v_mov_b32 v80, v88
    v_mov_b32 v88, 0xff800000
    v_and_b32_dpp v32, v28, v8 quad_perm:[0,0,0,0] row_mask:0xf bank_mask:0xf
    v_and_b32_dpp v33, v28, v9 quad_perm:[0,0,0,0] row_mask:0xf bank_mask:0xf
    s_cmp_eq_u32 s41, 0
    s_cselect_b32 s37, 4, 3
    s_cselect_b32 s38, 1, 0
    s_branch L_vloop
.p2align 12
L_vloop:
L_w3:
    s_cbranch_execz L_w4
    s_add_u32 s46, s46, 1
    s_bfe_u32 s43, s46, 0x10000
    s_lshl_b32 s43, s43, 19
    s_bfe_u32 s6, s46, 0x10001
    s_lshl_b32 s6, s6, 12
    s_or_b32 s43, s43, s6
    s_xor_b32 s43, s43, s21
    s_cmp_lg_u32 s37, s38
    s_cbranch_scc1 L_v1
    s_mov_b32 s24, s84
    s_mov_b32 s25, s85
    v_mov_b32 v6, v7
L_v1:
    v_mfma_f32_16x16x16_bf16 v[16:19], v[32:33], a[0:1], v[16:19]
    v_mfma_f32_16x16x16_bf16 v[20:23], v[32:33], a[2:3], v[20:23]
    v_and_b32_dpp v34, v28, v8 quad_perm:[1,1,1,1] row_mask:0xf bank_mask:0xf
    v_and_b32_dpp v35, v28, v9 quad_perm:[1,1,1,1] row_mask:0xf bank_mask:0xf
    s_cmp_lg_u32 s44, 0
    s_cbranch_scc1 L_va0
    s_waitcnt vmcnt(3)
L_va0:
    s_cbranch_vccnz L_vb0
    s_waitcnt vmcnt(4)
L_vb0:
    s_waitcnt vmcnt(5)
    buffer_load_dwordx4 a[0:3], v6, s[24:27], s43 offen offset:0 nt
    ds_read_b32 v37, v38 offset:28960
    v_fma_f32 v12, v65, s45, -v10
    v_exp_f32 v12, v12
    v_mov_b32 v65, v73
L_w4:
    s_cbranch_execz L_w5
    v_mfma_f32_16x16x16_bf16 v[16:19], v[34:35], a[4:5], v[16:19]
    v_mfma_f32_16x16x16_bf16 v[20:23], v[34:35], a[6:7], v[20:23]
    v_and_b32_dpp v32, v28, v8 quad_perm:[2,2,2,2] row_mask:0xf bank_mask:0xf
    v_and_b32_dpp v33, v28, v9 quad_perm:[2,2,2,2] row_mask:0xf bank_mask:0xf
    s_cbranch_vccnz L_vb1
    s_waitcnt vmcnt(4)
L_vb1:
    s_waitcnt vmcnt(5)
    s_xor_b32 s40, s43, 0x2000
    buffer_load_dwordx4 a[4:7], v6, s[24:27], s40 offen offset:0 nt
    s_waitcnt lgkmcnt(0)
    v_cmp_eq_u32 vcc, 2, v37
    v_readfirstlane_b32 s44, v37
    v_cvt_pk_bf16_f32 v29, v12, v12
    v_mov_b32 v73, v81
    v_mfma_f32_16x16x16_bf16 v[16:19], v[32:33], a[8:9], v[16:19]
    v_mfma_f32_16x16x16_bf16 v[20:23], v[32:33], a[10:11], v[20:23]
    v_and_b32_dpp v34, v28, v8 quad_perm:[3,3,3,3] row_mask:0xf bank_mask:0xf
    v_and_b32_dpp v35, v28, v9 quad_perm:[3,3,3,3] row_mask:0xf bank_mask:0xf
    s_cbranch_vccnz L_vb2
    s_waitcnt vmcnt(4)
L_vb2:
    s_waitcnt vmcnt(5)
    s_xor_b32 s40, s43, 0x40000
    buffer_load_dwordx4 a[8:11], v6, s[24:27], s40 offen offset:0 nt
    v_add_f32 v11, v11, v12
    v_mov_b32 v81, v89
L_w5:
    s_cbranch_execz L_w6
    v_mfma_f32_16x16x16_bf16 v[16:19], v[34:35], a[12:13], v[16:19]
    v_mfma_f32_16x16x16_bf16 v[20:23], v[34:35], a[14:15], v[20:23]
    v_and_b32_dpp v32, v29, v8 quad_perm:[0,0,0,0] row_mask:0xf bank_mask:0xf
    v_and_b32_dpp v33, v29, v9 quad_perm:[0,0,0,0] row_mask:0xf bank_mask:0xf
    s_cbranch_vccnz L_vb3
    s_waitcnt vmcnt(4)
L_vb3:
    s_waitcnt vmcnt(5)
    s_xor_b32 s40, s43, 0x42000
    buffer_load_dwordx4 a[12:15], v6, s[24:27], s40 offen offset:0 nt
    v_add_u32 v36, 4, v36
    ds_write_b32 v38, v36 offset:28944
    v_mfma_f32_16x16x16_bf16 v[16:19], v[32:33], a[16:17], v[16:19]
    v_mfma_f32_16x16x16_bf16 v[20:23], v[32:33], a[18:19], v[20:23]
    v_and_b32_dpp v34, v29, v8 quad_perm:[1,1,1,1] row_mask:0xf bank_mask:0xf
    v_and_b32_dpp v35, v29, v9 quad_perm:[1,1,1,1] row_mask:0xf bank_mask:0xf
    s_cmp_lg_u32 s44, 0
    s_cbranch_scc1 L_va4
    s_waitcnt vmcnt(3)
L_va4:
    s_cbranch_vccnz L_vb4
    s_waitcnt vmcnt(4)
L_vb4:
    s_waitcnt vmcnt(5)
    s_xor_b32 s40, s43, 0x4000
    buffer_load_dwordx4 a[16:19], v6, s[24:27], s40 offen offset:0 nt
    v_fma_f32 v12, v66, s45, -v10
    v_exp_f32 v12, v12
    v_mov_b32 v66, v74
L_w6:
    s_cbranch_execz L_w7
    v_mfma_f32_16x16x16_bf16 v[16:19], v[34:35], a[20:21], v[16:19]
    v_mfma_f32_16x16x16_bf16 v[20:23], v[34:35], a[22:23], v[20:23]
    v_and_b32_dpp v32, v29, v8 quad_perm:[2,2,2,2] row_mask:0xf bank_mask:0xf
    v_and_b32_dpp v33, v29, v9 quad_perm:[2,2,2,2] row_mask:0xf bank_mask:0xf
    s_cbranch_vccnz L_vb5
    s_waitcnt vmcnt(4)
L_vb5:
    s_waitcnt vmcnt(5)
    s_xor_b32 s40, s43, 0x6000
    buffer_load_dwordx4 a[20:23], v6, s[24:27], s40 offen offset:0 nt
    v_cvt_pk_bf16_f32 v28, v12, v12
    v_mov_b32 v74, v82
    v_mfma_f32_16x16x16_bf16 v[16:19], v[32:33], a[24:25], v[16:19]
    v_mfma_f32_16x16x16_bf16 v[20:23], v[32:33], a[26:27], v[20:23]
    v_and_b32_dpp v34, v29, v8 quad_perm:[3,3,3,3] row_mask:0xf bank_mask:0xf
    v_and_b32_dpp v35, v29, v9 quad_perm:[3,3,3,3] row_mask:0xf bank_mask:0xf
    s_cbranch_vccnz L_vb6
    s_waitcnt vmcnt(4)
L_vb6:
    s_waitcnt vmcnt(5)
    s_xor_b32 s40, s43, 0x44000
    buffer_load_dwordx4 a[24:27], v6, s[24:27], s40 offen offset:0 nt
    v_add_f32 v11, v11, v12
    v_mov_b32 v82, v90
L_w7:
    s_cbranch_execz L_w8
    v_mfma_f32_16x16x16_bf16 v[16:19], v[34:35], a[28:29], v[16:19]
    v_mfma_f32_16x16x16_bf16 v[20:23], v[34:35], a[30:31], v[20:23]
    v_and_b32_dpp v32, v28, v8 quad_perm:[0,0,0,0] row_mask:0xf bank_mask:0xf
    v_and_b32_dpp v33, v28, v9 quad_perm:[0,0,0,0] row_mask:0xf bank_mask:0xf
    s_cbranch_vccnz L_vb7
    s_waitcnt vmcnt(4)
L_vb7:
    s_waitcnt vmcnt(5)
    s_xor_b32 s40, s43, 0x46000
    buffer_load_dwordx4 a[28:31], v6, s[24:27], s40 offen offset:0 nt
    v_add_u32 v36, 4, v36
    ds_write_b32 v38, v36 offset:28944
    v_mfma_f32_16x16x16_bf16 v[16:19], v[32:33], a[32:33], v[16:19]
    v_mfma_f32_16x16x16_bf16 v[20:23], v[32:33], a[34:35], v[20:23]
    v_and_b32_dpp v34, v28, v8 quad_perm:[1,1,1,1] row_mask:0xf bank_mask:0xf
    v_and_b32_dpp v35, v28, v9 quad_perm:[1,1,1,1] row_mask:0xf bank_mask:0xf
    s_cmp_lg_u32 s44, 0
    s_cbranch_scc1 L_va8
    s_waitcnt vmcnt(3)
L_va8:
    s_cbranch_vccnz L_vb8
    s_waitcnt vmcnt(4)
L_vb8:
    s_waitcnt vmcnt(5)
    s_xor_b32 s40, s43, 0x100
    buffer_load_dwordx4 a[32:35], v6, s[24:27], s40 offen offset:0 nt
    ds_read_b32 v37, v38 offset:28960
    v_fma_f32 v12, v67, s45, -v10
    v_exp_f32 v12, v12
    v_mov_b32 v67, v75
L_w8:
    s_cbranch_execz L_w9
    v_mfma_f32_16x16x16_bf16 v[16:19], v[34:35], a[36:37], v[16:19]
    v_mfma_f32_16x16x16_bf16 v[20:23], v[34:35], a[38:39], v[20:23]
    v_and_b32_dpp v32, v28, v8 quad_perm:[2,2,2,2] row_mask:0xf bank_mask:0xf
    v_and_b32_dpp v33, v28, v9 quad_perm:[2,2,2,2] row_mask:0xf bank_mask:0xf
    s_cbranch_vccnz L_vb9
    s_waitcnt vmcnt(4)
L_vb9:
    s_waitcnt vmcnt(5)
    s_xor_b32 s40, s43, 0x2100
    buffer_load_dwordx4 a[36:39], v6, s[24:27], s40 offen offset:0 nt
    s_waitcnt lgkmcnt(0)
    v_cmp_eq_u32 vcc, 2, v37
    v_readfirstlane_b32 s44, v37
    v_cvt_pk_bf16_f32 v29, v12, v12
    v_mov_b32 v75, v83
    v_mfma_f32_16x16x16_bf16 v[16:19], v[32:33], a[40:41], v[16:19]
    v_mfma_f32_16x16x16_bf16 v[20:23], v[32:33], a[42:43], v[20:23]
    v_and_b32_dpp v34, v28, v8 quad_perm:[3,3,3,3] row_mask:0xf bank_mask:0xf
    v_and_b32_dpp v35, v28, v9 quad_perm:[3,3,3,3] row_mask:0xf bank_mask:0xf
    s_cbranch_vccnz L_vb10
    s_waitcnt vmcnt(4)
L_vb10:
    s_waitcnt vmcnt(5)
    s_xor_b32 s40, s43, 0x40100
    buffer_load_dwordx4 a[40:43], v6, s[24:27], s40 offen offset:0 nt
    v_add_f32 v11, v11, v12
    v_mov_b32 v83, v91
L_w9:
    s_cbranch_execz L_w10
    v_mfma_f32_16x16x16_bf16 v[16:19], v[34:35], a[44:45], v[16:19]
    v_mfma_f32_16x16x16_bf16 v[20:23], v[34:35], a[46:47], v[20:23]
    v_and_b32_dpp v32, v29, v8 quad_perm:[0,0,0,0] row_mask:0xf bank_mask:0xf
    v_and_b32_dpp v33, v29, v9 quad_perm:[0,0,0,0] row_mask:0xf bank_mask:0xf
    s_cbranch_vccnz L_vb11
    s_waitcnt vmcnt(4)
L_vb11:
    s_waitcnt vmcnt(5)
    s_xor_b32 s40, s43, 0x42100
    buffer_load_dwordx4 a[44:47], v6, s[24:27], s40 offen offset:0 nt
    v_add_u32 v36, 4, v36
    ds_write_b32 v38, v36 offset:28944
    v_mfma_f32_16x16x16_bf16 v[16:19], v[32:33], a[48:49], v[16:19]
    v_mfma_f32_16x16x16_bf16 v[20:23], v[32:33], a[50:51], v[20:23]
    v_and_b32_dpp v34, v29, v8 quad_perm:[1,1,1,1] row_mask:0xf bank_mask:0xf
    v_and_b32_dpp v35, v29, v9 quad_perm:[1,1,1,1] row_mask:0xf bank_mask:0xf
    s_cmp_lg_u32 s44, 0
    s_cbranch_scc1 L_va12
    s_waitcnt vmcnt(3)
L_va12:
    s_cbranch_vccnz L_vb12
    s_waitcnt vmcnt(4)
L_vb12:
    s_waitcnt vmcnt(5)
    s_xor_b32 s40, s43, 0x4100
    buffer_load_dwordx4 a[48:51], v6, s[24:27], s40 offen offset:0 nt
    v_fma_f32 v12, v68, s45, -v10
    v_exp_f32 v12, v12
    v_mov_b32 v68, v76
L_w10:
    s_cbranch_execz L_w11
    v_mfma_f32_16x16x16_bf16 v[16:19], v[34:35], a[52:53], v[16:19]
    v_mfma_f32_16x16x16_bf16 v[20:23], v[34:35], a[54:55], v[20:23]
    v_and_b32_dpp v32, v29, v8 quad_perm:[2,2,2,2] row_mask:0xf bank_mask:0xf
    v_and_b32_dpp v33, v29, v9 quad_perm:[2,2,2,2] row_mask:0xf bank_mask:0xf
    s_cbranch_vccnz L_vb13
    s_waitcnt vmcnt(4)
L_vb13:
    s_waitcnt vmcnt(5)
    s_xor_b32 s40, s43, 0x6100
    buffer_load_dwordx4 a[52:55], v6, s[24:27], s40 offen offset:0 nt
    v_cvt_pk_bf16_f32 v28, v12, v12
    v_mov_b32 v76, v84
    v_mfma_f32_16x16x16_bf16 v[16:19], v[32:33], a[56:57], v[16:19]
    v_mfma_f32_16x16x16_bf16 v[20:23], v[32:33], a[58:59], v[20:23]
    v_and_b32_dpp v34, v29, v8 quad_perm:[3,3,3,3] row_mask:0xf bank_mask:0xf
    v_and_b32_dpp v35, v29, v9 quad_perm:[3,3,3,3] row_mask:0xf bank_mask:0xf
    s_cbranch_vccnz L_vb14
    s_waitcnt vmcnt(4)
L_vb14:
    s_waitcnt vmcnt(5)
    s_xor_b32 s40, s43, 0x44100
    buffer_load_dwordx4 a[56:59], v6, s[24:27], s40 offen offset:0 nt
    v_add_f32 v11, v11, v12
    v_mov_b32 v84, v92
L_w11:
    s_cbranch_execz L_w12
    v_mfma_f32_16x16x16_bf16 v[16:19], v[34:35], a[60:61], v[16:19]
    v_mfma_f32_16x16x16_bf16 v[20:23], v[34:35], a[62:63], v[20:23]
    v_and_b32_dpp v32, v28, v8 quad_perm:[0,0,0,0] row_mask:0xf bank_mask:0xf
    v_and_b32_dpp v33, v28, v9 quad_perm:[0,0,0,0] row_mask:0xf bank_mask:0xf
    s_cbranch_vccnz L_vb15
    s_waitcnt vmcnt(4)
L_vb15:
    s_waitcnt vmcnt(5)
    s_xor_b32 s40, s43, 0x46100
    buffer_load_dwordx4 a[60:63], v6, s[24:27], s40 offen offset:0 nt
    v_add_u32 v36, 4, v36
    ds_write_b32 v38, v36 offset:28944
    v_mfma_f32_16x16x16_bf16 v[16:19], v[32:33], a[64:65], v[16:19]
    v_mfma_f32_16x16x16_bf16 v[20:23], v[32:33], a[66:67], v[20:23]
    v_and_b32_dpp v34, v28, v8 quad_perm:[1,1,1,1] row_mask:0xf bank_mask:0xf
    v_and_b32_dpp v35, v28, v9 quad_perm:[1,1,1,1] row_mask:0xf bank_mask:0xf
    s_cmp_lg_u32 s44, 0
    s_cbranch_scc1 L_va16
    s_waitcnt vmcnt(3)
L_va16:
    s_cbranch_vccnz L_vb16
    s_waitcnt vmcnt(4)
L_vb16:
    s_waitcnt vmcnt(5)
    s_xor_b32 s40, s43, 0x20000
    buffer_load_dwordx4 a[64:67], v6, s[24:27], s40 offen offset:0 nt
    ds_read_b32 v37, v38 offset:28960
    v_fma_f32 v12, v69, s45, -v10
    v_exp_f32 v12, v12
    v_mov_b32 v69, v77
L_w12:
    s_cbranch_execz L_w13
    v_mfma_f32_16x16x16_bf16 v[16:19], v[34:35], a[68:69], v[16:19]
    v_mfma_f32_16x16x16_bf16 v[20:23], v[34:35], a[70:71], v[20:23]
    v_and_b32_dpp v32, v28, v8 quad_perm:[2,2,2,2] row_mask:0xf bank_mask:0xf
    v_and_b32_dpp v33, v28, v9 quad_perm:[2,2,2,2] row_mask:0xf bank_mask:0xf
    s_cbranch_vccnz L_vb17
    s_waitcnt vmcnt(4)
L_vb17:
    s_waitcnt vmcnt(5)
    s_xor_b32 s40, s43, 0x22000
    buffer_load_dwordx4 a[68:71], v6, s[24:27], s40 offen offset:0 nt
    s_waitcnt lgkmcnt(0)
    v_cmp_eq_u32 vcc, 2, v37
    v_readfirstlane_b32 s44, v37
    v_cvt_pk_bf16_f32 v29, v12, v12
    v_mov_b32 v77, v85
    v_mfma_f32_16x16x16_bf16 v[16:19], v[32:33], a[72:73], v[16:19]
    v_mfma_f32_16x16x16_bf16 v[20:23], v[32:33], a[74:75], v[20:23]
    v_and_b32_dpp v34, v28, v8 quad_perm:[3,3,3,3] row_mask:0xf bank_mask:0xf
    v_and_b32_dpp v35, v28, v9 quad_perm:[3,3,3,3] row_mask:0xf bank_mask:0xf
    s_cbranch_vccnz L_vb18
    s_waitcnt vmcnt(4)
L_vb18:
    s_waitcnt vmcnt(5)
    s_xor_b32 s40, s43, 0x60000
    buffer_load_dwordx4 a[72:75], v6, s[24:27], s40 offen offset:0 nt
    v_add_f32 v11, v11, v12
    v_mov_b32 v85, v93
L_w13:
    s_cbranch_execz L_w14
    v_mfma_f32_16x16x16_bf16 v[16:19], v[34:35], a[76:77], v[16:19]
    v_mfma_f32_16x16x16_bf16 v[20:23], v[34:35], a[78:79], v[20:23]
    v_and_b32_dpp v32, v29, v8 quad_perm:[0,0,0,0] row_mask:0xf bank_mask:0xf
    v_and_b32_dpp v33, v29, v9 quad_perm:[0,0,0,0] row_mask:0xf bank_mask:0xf
    s_cbranch_vccnz L_vb19
    s_waitcnt vmcnt(4)
L_vb19:
    s_waitcnt vmcnt(5)
    s_xor_b32 s40, s43, 0x62000
    buffer_load_dwordx4 a[76:79], v6, s[24:27], s40 offen offset:0 nt
    v_add_u32 v36, 4, v36
    ds_write_b32 v38, v36 offset:28944
    v_mfma_f32_16x16x16_bf16 v[16:19], v[32:33], a[80:81], v[16:19]
    v_mfma_f32_16x16x16_bf16 v[20:23], v[32:33], a[82:83], v[20:23]
    v_and_b32_dpp v34, v29, v8 quad_perm:[1,1,1,1] row_mask:0xf bank_mask:0xf
    v_and_b32_dpp v35, v29, v9 quad_perm:[1,1,1,1] row_mask:0xf bank_mask:0xf
    s_cmp_lg_u32 s44, 0
    s_cbranch_scc1 L_va20
    s_waitcnt vmcnt(3)
L_va20:
    s_cbranch_vccnz L_vb20
    s_waitcnt vmcnt(4)
L_vb20:
    s_waitcnt vmcnt(5)
    s_xor_b32 s40, s43, 0x24000
    buffer_load_dwordx4 a[80:83], v6, s[24:27], s40 offen offset:0 nt
    v_fma_f32 v12, v70, s45, -v10
    v_exp_f32 v12, v12
    v_mov_b32 v70, v78
L_w14:
    s_cbranch_execz L_w15
    v_mfma_f32_16x16x16_bf16 v[16:19], v[34:35], a[84:85], v[16:19]
    v_mfma_f32_16x16x16_bf16 v[20:23], v[34:35], a[86:87], v[20:23]
    v_and_b32_dpp v32, v29, v8 quad_perm:[2,2,2,2] row_mask:0xf bank_mask:0xf
    v_and_b32_dpp v33, v29, v9 quad_perm:[2,2,2,2] row_mask:0xf bank_mask:0xf
    s_cbranch_vccnz L_vb21
    s_waitcnt vmcnt(4)
L_vb21:
    s_waitcnt vmcnt(5)
    s_xor_b32 s40, s43, 0x26000
    buffer_load_dwordx4 a[84:87], v6, s[24:27], s40 offen offset:0 nt
    v_cvt_pk_bf16_f32 v28, v12, v12
    v_mov_b32 v78, v86
    v_mfma_f32_16x16x16_bf16 v[16:19], v[32:33], a[88:89], v[16:19]
    v_mfma_f32_16x16x16_bf16 v[20:23], v[32:33], a[90:91], v[20:23]
    v_and_b32_dpp v34, v29, v8 quad_perm:[3,3,3,3] row_mask:0xf bank_mask:0xf
    v_and_b32_dpp v35, v29, v9 quad_perm:[3,3,3,3] row_mask:0xf bank_mask:0xf
    s_cbranch_vccnz L_vb22
    s_waitcnt vmcnt(4)
L_vb22:
    s_waitcnt vmcnt(5)
    s_xor_b32 s40, s43, 0x64000
    buffer_load_dwordx4 a[88:91], v6, s[24:27], s40 offen offset:0 nt
    v_add_f32 v11, v11, v12
    v_mov_b32 v86, v94
L_w15:
    s_cbranch_execz L_w16
    v_mfma_f32_16x16x16_bf16 v[16:19], v[34:35], a[92:93], v[16:19]
    v_mfma_f32_16x16x16_bf16 v[20:23], v[34:35], a[94:95], v[20:23]
    v_and_b32_dpp v32, v28, v8 quad_perm:[0,0,0,0] row_mask:0xf bank_mask:0xf
    v_and_b32_dpp v33, v28, v9 quad_perm:[0,0,0,0] row_mask:0xf bank_mask:0xf
    s_cbranch_vccnz L_vb23
    s_waitcnt vmcnt(4)
L_vb23:
    s_waitcnt vmcnt(5)
    s_xor_b32 s40, s43, 0x66000
    buffer_load_dwordx4 a[92:95], v6, s[24:27], s40 offen offset:0 nt
    v_add_u32 v36, 4, v36
    ds_write_b32 v38, v36 offset:28944
    v_mfma_f32_16x16x16_bf16 v[16:19], v[32:33], a[96:97], v[16:19]
    v_mfma_f32_16x16x16_bf16 v[20:23], v[32:33], a[98:99], v[20:23]
    v_and_b32_dpp v34, v28, v8 quad_perm:[1,1,1,1] row_mask:0xf bank_mask:0xf
    v_and_b32_dpp v35, v28, v9 quad_perm:[1,1,1,1] row_mask:0xf bank_mask:0xf
    s_cmp_lg_u32 s44, 0
    s_cbranch_scc1 L_va24
    s_waitcnt vmcnt(3)
L_va24:
    s_cbranch_vccnz L_vb24
    s_waitcnt vmcnt(4)
L_vb24:
    s_waitcnt vmcnt(5)
    s_xor_b32 s40, s43, 0x20100
    buffer_load_dwordx4 a[96:99], v6, s[24:27], s40 offen offset:0 nt
    ds_read_b32 v37, v38 offset:28960
    v_fma_f32 v12, v71, s45, -v10
    v_exp_f32 v12, v12
    v_mov_b32 v71, v79
L_w16:
    s_cbranch_execz L_w17
    v_mfma_f32_16x16x16_bf16 v[16:19], v[34:35], a[100:101], v[16:19]
    v_mfma_f32_16x16x16_bf16 v[20:23], v[34:35], a[102:103], v[20:23]
    v_and_b32_dpp v32, v28, v8 quad_perm:[2,2,2,2] row_mask:0xf bank_mask:0xf
    v_and_b32_dpp v33, v28, v9 quad_perm:[2,2,2,2] row_mask:0xf bank_mask:0xf
    s_cbranch_vccnz L_vb25
    s_waitcnt vmcnt(4)
L_vb25:
    s_waitcnt vmcnt(5)
    s_xor_b32 s40, s43, 0x22100
    buffer_load_dwordx4 a[100:103], v6, s[24:27], s40 offen offset:0 nt
    s_waitcnt lgkmcnt(0)
    v_cmp_eq_u32 vcc, 2, v37
    v_readfirstlane_b32 s44, v37
    v_cvt_pk_bf16_f32 v29, v12, v12
    v_mov_b32 v79, v87
    v_mfma_f32_16x16x16_bf16 v[16:19], v[32:33], a[104:105], v[16:19]
    v_mfma_f32_16x16x16_bf16 v[20:23], v[32:33], a[106:107], v[20:23]
    v_and_b32_dpp v34, v28, v8 quad_perm:[3,3,3,3] row_mask:0xf bank_mask:0xf
    v_and_b32_dpp v35, v28, v9 quad_perm:[3,3,3,3] row_mask:0xf bank_mask:0xf
    s_cbranch_vccnz L_vb26
    s_waitcnt vmcnt(4)
L_vb26:
    s_waitcnt vmcnt(5)
    s_xor_b32 s40, s43, 0x60100
    buffer_load_dwordx4 a[104:107], v6, s[24:27], s40 offen offset:0 nt
    v_add_f32 v11, v11, v12
    v_mov_b32 v87, v95
L_w17:
    s_cbranch_execz L_w18
    v_mfma_f32_16x16x16_bf16 v[16:19], v[34:35], a[108:109], v[16:19]
    v_mfma_f32_16x16x16_bf16 v[20:23], v[34:35], a[110:111], v[20:23]
    v_and_b32_dpp v32, v29, v8 quad_perm:[0,0,0,0] row_mask:0xf bank_mask:0xf
    v_and_b32_dpp v33, v29, v9 quad_perm:[0,0,0,0] row_mask:0xf bank_mask:0xf
    s_cbranch_vccnz L_vb27
    s_waitcnt vmcnt(4)
L_vb27:
    s_waitcnt vmcnt(5)
    s_xor_b32 s40, s43, 0x62100
    buffer_load_dwordx4 a[108:111], v6, s[24:27], s40 offen offset:0 nt
    v_add_u32 v36, 4, v36
    ds_write_b32 v38, v36 offset:28944
    v_mfma_f32_16x16x16_bf16 v[16:19], v[32:33], a[112:113], v[16:19]
    v_mfma_f32_16x16x16_bf16 v[20:23], v[32:33], a[114:115], v[20:23]
    v_and_b32_dpp v34, v29, v8 quad_perm:[1,1,1,1] row_mask:0xf bank_mask:0xf
    v_and_b32_dpp v35, v29, v9 quad_perm:[1,1,1,1] row_mask:0xf bank_mask:0xf
    s_cmp_lg_u32 s44, 0
    s_cbranch_scc1 L_va28
    s_waitcnt vmcnt(3)
L_va28:
    s_cbranch_vccnz L_vb28
    s_waitcnt vmcnt(4)
L_vb28:
    s_waitcnt vmcnt(5)
    s_xor_b32 s40, s43, 0x24100
    buffer_load_dwordx4 a[112:115], v6, s[24:27], s40 offen offset:0 nt
    v_fma_f32 v12, v64, s45, -v10
    v_exp_f32 v12, v12
    v_mov_b32 v64, v72
L_w18:
    s_cbranch_execz L_w19
    v_mfma_f32_16x16x16_bf16 v[16:19], v[34:35], a[116:117], v[16:19]
    v_mfma_f32_16x16x16_bf16 v[20:23], v[34:35], a[118:119], v[20:23]
    v_and_b32_dpp v32, v29, v8 quad_perm:[2,2,2,2] row_mask:0xf bank_mask:0xf
    v_and_b32_dpp v33, v29, v9 quad_perm:[2,2,2,2] row_mask:0xf bank_mask:0xf
    s_cbranch_vccnz L_vb29
    s_waitcnt vmcnt(4)
L_vb29:
    s_waitcnt vmcnt(5)
    s_xor_b32 s40, s43, 0x26100
    buffer_load_dwordx4 a[116:119], v6, s[24:27], s40 offen offset:0 nt
    v_cvt_pk_bf16_f32 v28, v12, v12
    v_mov_b32 v72, v80
    v_mfma_f32_16x16x16_bf16 v[16:19], v[32:33], a[120:121], v[16:19]
    v_mfma_f32_16x16x16_bf16 v[20:23], v[32:33], a[122:123], v[20:23]
    v_and_b32_dpp v34, v29, v8 quad_perm:[3,3,3,3] row_mask:0xf bank_mask:0xf
    v_and_b32_dpp v35, v29, v9 quad_perm:[3,3,3,3] row_mask:0xf bank_mask:0xf
    s_cbranch_vccnz L_vb30
    s_waitcnt vmcnt(4)
L_vb30:
    s_waitcnt vmcnt(5)
    s_xor_b32 s40, s43, 0x64100
    buffer_load_dwordx4 a[120:123], v6, s[24:27], s40 offen offset:0 nt
    v_add_f32 v11, v11, v12
    v_mov_b32 v80, v88
    v_mov_b32 v88, 0xff800000
L_w19:
    s_cbranch_execz L_w20
    v_mfma_f32_16x16x16_bf16 v[16:19], v[34:35], a[124:125], v[16:19]
    v_mfma_f32_16x16x16_bf16 v[20:23], v[34:35], a[126:127], v[20:23]
    v_and_b32_dpp v32, v28, v8 quad_perm:[0,0,0,0] row_mask:0xf bank_mask:0xf
    v_and_b32_dpp v33, v28, v9 quad_perm:[0,0,0,0] row_mask:0xf bank_mask:0xf
    s_cbranch_vccnz L_vb31
    s_waitcnt vmcnt(4)
L_vb31:
    s_waitcnt vmcnt(5)
    s_xor_b32 s40, s43, 0x66100
    buffer_load_dwordx4 a[124:127], v6, s[24:27], s40 offen offset:0 nt
    v_add_u32 v36, 4, v36
    ds_write_b32 v38, v36 offset:28944
    s_sub_u32 s37, s37, 1
    s_cmp_lg_u32 s37, 0
    s_cbranch_scc1 L_vloop
    s_cmp_lg_u32 s41, 0
    s_cbranch_scc1 L_last
L_qbw:
    ds_read_b32 v13, v62 offset:28928
    ds_read_b128 v[24:27], v2 offset:25856
    s_waitcnt lgkmcnt(0)
    v_readfirstlane_b32 s10, v13
    v_cmp_eq_u32 vcc, 0, v13
    s_cbranch_vccnz L_qbw
L_w20:
    s_cbranch_execz L_w21
    v_add_f32_dpp v11, v11, v11 quad_perm:[1,0,3,2] row_mask:0xf bank_mask:0xf
    s_nop 1
    v_add_f32_dpp v11, v11, v11 quad_perm:[2,3,0,1] row_mask:0xf bank_mask:0xf
    v_mov_b32 v12, v11
    s_nop 1
    v_permlane16_swap_b32 v12, v11
    v_add_f32 v11, v11, v12
    v_mov_b32 v12, v11
    s_nop 1
    v_permlane32_swap_b32 v12, v11
    v_add_f32 v11, v11, v12
    ds_write2_b32 v60, v16, v17 offset0:0 offset1:1
    ds_write2_b32 v60, v18, v19 offset0:2 offset1:16
    ds_write2_b32 v60, v20, v21 offset0:17 offset1:18
    ds_write2_b32 v60, v22, v23 offset0:32 offset1:33
    ds_write_b64 v61, v[10:11] offset:24704
    s_mov_b64 exec, 1
    s_waitcnt lgkmcnt(0)
    ds_add_u32 v62, v63 offset:28932
    s_mov_b64 exec, -1
    v_subrev_u32 v60, 12288, v60
    s_mov_b32 s41, 1
    s_branch L_branch
.p2align 6
L_h2nd:
    s_mov_b64 exec, -1
    s_lshl_b32 s36, s3, 10
    s_add_u32 s36, s36, 98304
    s_lshl_b32 s37, s4, 4
    s_add_u32 s37, s37, s36
    v_and_b32 v57, 31, v1
    v_lshlrev_b32 v57, 4, v57
    s_mov_b32 s39, 200000
    s_mov_b32 s40, 4
    v_mov_b32 v31, s47
    v_min_u32 v62, 47, v1
    v_lshlrev_b32 v62, 4, v62
    v_mov_b32 v61, 0
    s_mov_b32 s44, 0x3f800000
    s_mov_b32 s45, 0xc0c00000
    s_add_u32 s12, s22, 2097152
    s_addc_u32 s13, s23, 0
    s_mov_b32 s14, 48
    s_mov_b32 s15, 0
    s_mov_b32 s16, 0x3f400000
    s_mov_b32 s17, 0xc0100000
L_fb:
    ds_read_b128 v[80:83], v14 offset:28944
    ds_read_b32 v88, v58 offset:28944
    ds_read_b32 v89, v14 offset:28932
    s_waitcnt lgkmcnt(0)
    v_min3_u32 v90, v80, v81, v82
    v_min_u32 v90, v90, v83
    v_readfirstlane_b32 s38, v89
    v_readfirstlane_b32 s41, v90
    v_add_u32 v80, s47, v80
    v_add_u32 v81, s47, v81
    v_add_u32 v82, s47, v82
    v_add_u32 v83, s47, v83
    s_mov_b64 exec, 1
    buffer_store_dwordx4 v[80:83], v14, s[32:35], s37 offen
    s_mov_b64 exec, -1
    buffer_load_dwordx4 v[84:87], v57, s[32:35], s36 offen sc1
    buffer_load_dwordx2 v[94:95], v14, s[32:35], s36 offen offset:512 sc1
    s_cmp_lt_u32 s38, 4
    s_cbranch_scc1 L_fb1
    s_cmp_eq_u32 s40, 0
    s_cbranch_scc1 L_fb1
L_ah:
    ds_read_b128 v[16:19], v61 offset:24704
    ds_read_b128 v[20:23], v61 offset:24720
    ds_read_b128 v[32:35], v62 offset:12288
    ds_read_b128 v[36:39], v62 offset:15360
    ds_read_b128 v[40:43], v62 offset:18432
    ds_read_b128 v[44:47], v62 offset:21504
    s_waitcnt lgkmcnt(4)
    v_max3_f32 v24, v16, v18, v20
    v_max_f32 v24, v24, v22
    v_sub_f32 v16, v16, v24
    v_sub_f32 v18, v18, v24
    v_sub_f32 v20, v20, v24
    v_sub_f32 v22, v22, v24
    v_exp_f32 v16, v16
    v_exp_f32 v18, v18
    v_exp_f32 v20, v20
    v_exp_f32 v22, v22
    v_mul_f32 v25, v16, v17
    v_fmac_f32 v25, v18, v19
    v_fmac_f32 v25, v20, v21
    v_fmac_f32 v25, v22, v23
    v_rcp_f32 v26, v25
    v_log_f32 v27, v25
    s_waitcnt lgkmcnt(0)
    v_mul_f32 v28, v16, v32
    v_mul_f32 v29, v16, v33
    v_mul_f32 v30, v16, v34
    v_fmac_f32 v28, v18, v36
    v_fmac_f32 v29, v18, v37
    v_fmac_f32 v30, v18, v38
    v_fmac_f32 v28, v20, v40
    v_fmac_f32 v29, v20, v41
    v_fmac_f32 v30, v20, v42
    v_fmac_f32 v28, v22, v44
    v_fmac_f32 v29, v22, v45
    v_fmac_f32 v30, v22, v46
    v_add_f32 v27, v27, v24
    v_mul_f32 v28, v28, v26
    v_mul_f32 v29, v29, v26
    v_mul_f32 v30, v30, v26
    v_cndmask_b32 v30, v30, v27, s[58:59]
    v_mov_b32 v64, v68
    v_mov_b32 v65, v69
    v_mov_b32 v66, v70
    v_mov_b32 v67, v71
    v_mov_b32 v68, v72
    v_mov_b32 v69, v73
    v_mov_b32 v70, v74
    v_mov_b32 v71, v75
    v_mov_b32 v72, v76
    v_mov_b32 v73, v77
    v_mov_b32 v74, v78
    v_mov_b32 v75, v79
    v_mov_b32 v76, v28
    v_mov_b32 v77, v29
    v_mov_b32 v78, v30
    v_mov_b32 v79, v31
    v_add_u32 v61, 32, v61
    v_add_u32 v62, 768, v62
    s_sub_u32 s40, s40, 1
    s_cmp_lg_u32 s40, 0
    s_cbranch_scc1 L_ah
L_fb1:
    s_cmp_ge_u32 s41, 512
    s_cbranch_scc1 L_fbd
    s_sub_u32 s39, s39, 1
    s_cmp_eq_u32 s39, 0
    s_cbranch_scc1 L_fbd
    s_waitcnt vmcnt(0)
    v_subrev_u32 v84, s47, v84
    v_subrev_u32 v85, s47, v85
    v_subrev_u32 v86, s47, v86
    v_subrev_u32 v87, s47, v87
    v_max3_u32 v90, v84, v85, v86
    v_max_u32 v90, v90, v87
    v_add3_u32 v91, v84, v85, v86
    v_add_u32 v91, v91, v87
    v_cmp_ge_u32 vcc, 0x400, v90
    v_cvt_f32_u32 v91, v91
    v_mov_b32 v92, 4.0
    v_cndmask_b32 v91, 0, v91, vcc
    v_cndmask_b32 v92, 0, v92, vcc
    s_nop 0
    v_add_f32_dpp v91, v91, v91 row_ror:1 row_mask:0xf bank_mask:0xf
    v_add_f32_dpp v92, v92, v92 row_ror:1 row_mask:0xf bank_mask:0xf
    s_nop 0
    v_add_f32_dpp v91, v91, v91 row_ror:2 row_mask:0xf bank_mask:0xf
    v_add_f32_dpp v92, v92, v92 row_ror:2 row_mask:0xf bank_mask:0xf
    s_nop 0
    v_add_f32_dpp v91, v91, v91 row_ror:4 row_mask:0xf bank_mask:0xf
    v_add_f32_dpp v92, v92, v92 row_ror:4 row_mask:0xf bank_mask:0xf
    s_nop 0
    v_add_f32_dpp v91, v91, v91 row_ror:8 row_mask:0xf bank_mask:0xf
    v_add_f32_dpp v92, v92, v92 row_ror:8 row_mask:0xf bank_mask:0xf
    v_mov_b32 v93, v91
    s_nop 1
    v_permlane16_swap_b32 v93, v91
    v_add_f32 v91, v91, v93
    v_mov_b32 v93, v92
    s_nop 1
    v_permlane16_swap_b32 v93, v92
    v_add_f32 v92, v92, v93
    v_rcp_f32 v92, v92
    v_cvt_f32_u32 v88, v88
    v_mul_f32 v91, v91, v92
    s_cmp_ge_u32 s2, 8
    s_cbranch_scc1 L_nx
    v_cvt_u32_f32 v93, v91
    s_mov_b32 s18, 1
    v_readfirstlane_b32 s19, v93
    s_nop 3
    s_cmp_lt_u32 s19, s14
    s_cbranch_scc1 L_nx
    s_atomic_add s18, s[12:13], s15 glc
    s_add_u32 s15, s15, 4352
    s_add_u32 s14, s14, 24
    v_mov_b32 v93, s17
    s_waitcnt lgkmcnt(0)
    s_min_u32 s18, s18, 7
    v_cvt_f32_u32 v94, s18
    v_fma_f32 v94, v94, s16, v93
    v_mov_b32 v95, s47
    s_mov_b64 exec, 1
    buffer_store_dwordx2 v[94:95], v14, s[32:35], s36 offen offset:512
    s_mov_b64 exec, -1
L_nx:
    v_cmp_eq_u32 vcc, s47, v95
    v_sub_f32 v91, v91, v88
    s_nop 0
    v_cndmask_b32 v93, 0, v94, vcc
    v_add_f32 v91, v91, v93
    v_mov_b32 v92, 1
    v_cmp_lt_f32 vcc, s44, v91
    v_cmp_gt_f32 s[56:57], s45, v91
    s_nop 0
    v_cndmask_b32 v92, v92, 2, vcc
    v_cndmask_b32 v92, v92, 0, s[56:57]
    ds_write_b32 v58, v92 offset:28960
    s_branch L_fb
L_fbd:
    s_mov_b32 exec_hi, 0xffff
    s_cmp_lg_u32 s10, 1
    s_cbranch_scc1 L_al
    buffer_store_dwordx4 v[64:67], v3, s[32:35], s28 offen
    buffer_store_dwordx4 v[68:71], v3, s[32:35], s29 offen
    buffer_store_dwordx4 v[72:75], v3, s[32:35], s30 offen
    buffer_store_dwordx4 v[76:79], v3, s[32:35], s31 offen
L_al:
    s_barrier
    s_cmp_lg_u32 s10, 1
    s_cbranch_scc1 L_as
    s_branch L_ad
L_as:
    buffer_store_dwordx4 v[64:67], v3, s[32:35], s28 offen sc1
    buffer_store_dwordx4 v[68:71], v3, s[32:35], s29 offen sc1
    buffer_store_dwordx4 v[72:75], v3, s[32:35], s30 offen sc1
    buffer_store_dwordx4 v[76:79], v3, s[32:35], s31 offen sc1
L_ad:
    s_endpgm
.p2align 12
L_last:
L_w21:
    s_cbranch_execz L_w22
    v_mfma_f32_16x16x16_bf16 v[16:19], v[32:33], a[0:1], v[16:19]
    v_mfma_f32_16x16x16_bf16 v[20:23], v[32:33], a[2:3], v[20:23]
    v_and_b32_dpp v34, v28, v8 quad_perm:[1,1,1,1] row_mask:0xf bank_mask:0xf
    v_and_b32_dpp v35, v28, v9 quad_perm:[1,1,1,1] row_mask:0xf bank_mask:0xf
    v_lshrrev_b32 v58, 4, v1
    v_lshlrev_b32 v58, 11, v58
    v_fma_f32 v12, v65, s45, -v10
    v_exp_f32 v12, v12
    v_mfma_f32_16x16x16_bf16 v[16:19], v[34:35], a[4:5], v[16:19]
    v_mfma_f32_16x16x16_bf16 v[20:23], v[34:35], a[6:7], v[20:23]
    v_and_b32_dpp v32, v28, v8 quad_perm:[2,2,2,2] row_mask:0xf bank_mask:0xf
    v_and_b32_dpp v33, v28, v9 quad_perm:[2,2,2,2] row_mask:0xf bank_mask:0xf
    v_and_b32 v59, 15, v1
    v_lshl_add_u32 v58, v59, 4, v58
    v_cvt_pk_bf16_f32 v29, v12, v12
    v_add_f32 v11, v11, v12
L_w22:
    s_cbranch_execz L_w23
    v_mfma_f32_16x16x16_bf16 v[16:19], v[32:33], a[8:9], v[16:19]
    v_mfma_f32_16x16x16_bf16 v[20:23], v[32:33], a[10:11], v[20:23]
    v_and_b32_dpp v34, v28, v8 quad_perm:[3,3,3,3] row_mask:0xf bank_mask:0xf
    v_and_b32_dpp v35, v28, v9 quad_perm:[3,3,3,3] row_mask:0xf bank_mask:0xf
    v_lshrrev_b32 v56, 2, v1
    v_mul_u32_u24 v56, 768, v56
    v_mfma_f32_16x16x16_bf16 v[16:19], v[34:35], a[12:13], v[16:19]
    v_mfma_f32_16x16x16_bf16 v[20:23], v[34:35], a[14:15], v[20:23]
    v_and_b32_dpp v32, v29, v8 quad_perm:[0,0,0,0] row_mask:0xf bank_mask:0xf
    v_and_b32_dpp v33, v29, v9 quad_perm:[0,0,0,0] row_mask:0xf bank_mask:0xf
    v_and_b32 v59, 3, v1
    v_lshl_add_u32 v56, v59, 4, v56
L_w23:
    s_cbranch_execz L_w24
    v_mfma_f32_16x16x16_bf16 v[16:19], v[32:33], a[16:17], v[16:19]
    v_mfma_f32_16x16x16_bf16 v[20:23], v[32:33], a[18:19], v[20:23]
    v_and_b32_dpp v34, v29, v8 quad_perm:[1,1,1,1] row_mask:0xf bank_mask:0xf
    v_and_b32_dpp v35, v29, v9 quad_perm:[1,1,1,1] row_mask:0xf bank_mask:0xf
    s_lshl_b32 s37, s5, 5
    s_lshl_b32 s38, s3, 2
    v_fma_f32 v12, v66, s45, -v10
    v_exp_f32 v12, v12
    v_mfma_f32_16x16x16_bf16 v[16:19], v[34:35], a[20:21], v[16:19]
    v_mfma_f32_16x16x16_bf16 v[20:23], v[34:35], a[22:23], v[20:23]
    v_and_b32_dpp v32, v29, v8 quad_perm:[2,2,2,2] row_mask:0xf bank_mask:0xf
    v_and_b32_dpp v33, v29, v9 quad_perm:[2,2,2,2] row_mask:0xf bank_mask:0xf
    s_add_u32 s37, s37, s38
    s_bfe_u32 s38, s2, 0x20005
    v_cvt_pk_bf16_f32 v28, v12, v12
    v_add_f32 v11, v11, v12
L_w24:
    s_cbranch_execz L_w25
    v_mfma_f32_16x16x16_bf16 v[16:19], v[32:33], a[24:25], v[16:19]
    v_mfma_f32_16x16x16_bf16 v[20:23], v[32:33], a[26:27], v[20:23]
    v_and_b32_dpp v34, v29, v8 quad_perm:[3,3,3,3] row_mask:0xf bank_mask:0xf
    v_and_b32_dpp v35, v29, v9 quad_perm:[3,3,3,3] row_mask:0xf bank_mask:0xf
    s_add_u32 s60, s37, s38
    s_mul_i32 s37, s60, 24576
    v_mfma_f32_16x16x16_bf16 v[16:19], v[34:35], a[28:29], v[16:19]
    v_mfma_f32_16x16x16_bf16 v[20:23], v[34:35], a[30:31], v[20:23]
    v_and_b32_dpp v32, v28, v8 quad_perm:[0,0,0,0] row_mask:0xf bank_mask:0xf
    v_and_b32_dpp v33, v28, v9 quad_perm:[0,0,0,0] row_mask:0xf bank_mask:0xf
    s_mul_i32 s38, s20, 192
    s_add_u32 s37, s37, s38
L_w25:
    s_cbranch_execz L_w26
    v_mfma_f32_16x16x16_bf16 v[16:19], v[32:33], a[32:33], v[16:19]
    v_mfma_f32_16x16x16_bf16 v[20:23], v[32:33], a[34:35], v[20:23]
    v_and_b32_dpp v34, v28, v8 quad_perm:[1,1,1,1] row_mask:0xf bank_mask:0xf
    v_and_b32_dpp v35, v28, v9 quad_perm:[1,1,1,1] row_mask:0xf bank_mask:0xf
    s_add_u32 s37, s37, 524288
    s_add_u32 s38, s37, 12288
    v_fma_f32 v12, v67, s45, -v10
    v_exp_f32 v12, v12
    v_mfma_f32_16x16x16_bf16 v[16:19], v[34:35], a[36:37], v[16:19]
    v_mfma_f32_16x16x16_bf16 v[20:23], v[34:35], a[38:39], v[20:23]
    v_and_b32_dpp v32, v28, v8 quad_perm:[2,2,2,2] row_mask:0xf bank_mask:0xf
    v_and_b32_dpp v33, v28, v9 quad_perm:[2,2,2,2] row_mask:0xf bank_mask:0xf
    s_lshl_b32 s36, s62, 2
    s_add_u32 s36, s36, s20
    v_cvt_pk_bf16_f32 v29, v12, v12
    v_add_f32 v11, v11, v12
L_w26:
    s_cbranch_execz L_w27
    v_mfma_f32_16x16x16_bf16 v[16:19], v[32:33], a[40:41], v[16:19]
    v_mfma_f32_16x16x16_bf16 v[20:23], v[32:33], a[42:43], v[20:23]
    v_and_b32_dpp v34, v28, v8 quad_perm:[3,3,3,3] row_mask:0xf bank_mask:0xf
    v_and_b32_dpp v35, v28, v9 quad_perm:[3,3,3,3] row_mask:0xf bank_mask:0xf
    s_lshl_b32 s36, s36, 5
    s_add_u32 s36, s36, s63
    v_mfma_f32_16x16x16_bf16 v[16:19], v[34:35], a[44:45], v[16:19]
    v_mfma_f32_16x16x16_bf16 v[20:23], v[34:35], a[46:47], v[20:23]
    v_and_b32_dpp v32, v29, v8 quad_perm:[0,0,0,0] row_mask:0xf bank_mask:0xf
    v_and_b32_dpp v33, v29, v9 quad_perm:[0,0,0,0] row_mask:0xf bank_mask:0xf
    s_mul_i32 s36, s36, 768
    s_add_u32 s36, s36, 1310720
L_w27:
    s_cbranch_execz L_w28
    v_mfma_f32_16x16x16_bf16 v[16:19], v[32:33], a[48:49], v[16:19]
    v_mfma_f32_16x16x16_bf16 v[20:23], v[32:33], a[50:51], v[20:23]
    v_and_b32_dpp v34, v29, v8 quad_perm:[1,1,1,1] row_mask:0xf bank_mask:0xf
    v_and_b32_dpp v35, v29, v9 quad_perm:[1,1,1,1] row_mask:0xf bank_mask:0xf
    s_lshl_b32 s39, s20, 5
    v_mov_b32 v62, s39
    v_fma_f32 v12, v68, s45, -v10
    v_exp_f32 v12, v12
    v_mfma_f32_16x16x16_bf16 v[16:19], v[34:35], a[52:53], v[16:19]
    v_mfma_f32_16x16x16_bf16 v[20:23], v[34:35], a[54:55], v[20:23]
    v_and_b32_dpp v32, v29, v8 quad_perm:[2,2,2,2] row_mask:0xf bank_mask:0xf
    v_and_b32_dpp v33, v29, v9 quad_perm:[2,2,2,2] row_mask:0xf bank_mask:0xf
    s_mul_i32 s39, s20, 768
    v_min_u32 v63, 47, v1
    v_cvt_pk_bf16_f32 v28, v12, v12
    v_add_f32 v11, v11, v12
L_w28:
    s_cbranch_execz L_w29
    v_mfma_f32_16x16x16_bf16 v[16:19], v[32:33], a[56:57], v[16:19]
    v_mfma_f32_16x16x16_bf16 v[20:23], v[32:33], a[58:59], v[20:23]
    v_and_b32_dpp v34, v29, v8 quad_perm:[3,3,3,3] row_mask:0xf bank_mask:0xf
    v_and_b32_dpp v35, v29, v9 quad_perm:[3,3,3,3] row_mask:0xf bank_mask:0xf
    v_lshlrev_b32 v63, 4, v63
    v_add_u32 v63, s39, v63
    v_mfma_f32_16x16x16_bf16 v[16:19], v[34:35], a[60:61], v[16:19]
    v_mfma_f32_16x16x16_bf16 v[20:23], v[34:35], a[62:63], v[20:23]
    v_and_b32_dpp v32, v28, v8 quad_perm:[0,0,0,0] row_mask:0xf bank_mask:0xf
    v_and_b32_dpp v33, v28, v9 quad_perm:[0,0,0,0] row_mask:0xf bank_mask:0xf
    v_mov_b32 v31, s47
    s_mov_b32 s39, 200000
L_w29:
    s_cbranch_execz L_w30
    v_mfma_f32_16x16x16_bf16 v[16:19], v[32:33], a[64:65], v[16:19]
    v_mfma_f32_16x16x16_bf16 v[20:23], v[32:33], a[66:67], v[20:23]
    v_and_b32_dpp v34, v28, v8 quad_perm:[1,1,1,1] row_mask:0xf bank_mask:0xf
    v_and_b32_dpp v35, v28, v9 quad_perm:[1,1,1,1] row_mask:0xf bank_mask:0xf
    v_mul_u32_u24 v57, 768, v1
    s_and_b32 s61, s60, 0x3c
    v_fma_f32 v12, v69, s45, -v10
    v_exp_f32 v12, v12
    v_mfma_f32_16x16x16_bf16 v[16:19], v[34:35], a[68:69], v[16:19]
    v_mfma_f32_16x16x16_bf16 v[20:23], v[34:35], a[70:71], v[20:23]
    v_and_b32_dpp v32, v28, v8 quad_perm:[2,2,2,2] row_mask:0xf bank_mask:0xf
    v_and_b32_dpp v33, v28, v9 quad_perm:[2,2,2,2] row_mask:0xf bank_mask:0xf
    s_mul_i32 s61, s61, 24576
    s_add_u32 s61, s61, 524288
    v_cvt_pk_bf16_f32 v29, v12, v12
    v_add_f32 v11, v11, v12
L_w30:
    s_cbranch_execz L_w31
    v_mfma_f32_16x16x16_bf16 v[16:19], v[32:33], a[72:73], v[16:19]
    v_mfma_f32_16x16x16_bf16 v[20:23], v[32:33], a[74:75], v[20:23]
    v_and_b32_dpp v34, v28, v8 quad_perm:[3,3,3,3] row_mask:0xf bank_mask:0xf
    v_and_b32_dpp v35, v28, v9 quad_perm:[3,3,3,3] row_mask:0xf bank_mask:0xf
    s_nop 1
    v_mfma_f32_16x16x16_bf16 v[16:19], v[34:35], a[76:77], v[16:19]
    v_mfma_f32_16x16x16_bf16 v[20:23], v[34:35], a[78:79], v[20:23]
    v_and_b32_dpp v32, v29, v8 quad_perm:[0,0,0,0] row_mask:0xf bank_mask:0xf
    v_and_b32_dpp v33, v29, v9 quad_perm:[0,0,0,0] row_mask:0xf bank_mask:0xf
    s_nop 0
    buffer_load_dwordx4 a[128:131], v58, s[68:71], s42 offen offset:0 nt
L_w31:
    s_cbranch_execz L_w32
    v_mfma_f32_16x16x16_bf16 v[16:19], v[32:33], a[80:81], v[16:19]
    v_mfma_f32_16x16x16_bf16 v[20:23], v[32:33], a[82:83], v[20:23]
    v_and_b32_dpp v34, v29, v8 quad_perm:[1,1,1,1] row_mask:0xf bank_mask:0xf
    v_and_b32_dpp v35, v29, v9 quad_perm:[1,1,1,1] row_mask:0xf bank_mask:0xf
    s_nop 0
    buffer_load_dwordx4 a[132:135], v58, s[68:71], s42 offen offset:1024 nt
    v_fma_f32 v12, v70, s45, -v10
    v_exp_f32 v12, v12
    v_mfma_f32_16x16x16_bf16 v[16:19], v[34:35], a[84:85], v[16:19]
    v_mfma_f32_16x16x16_bf16 v[20:23], v[34:35], a[86:87], v[20:23]
    v_and_b32_dpp v32, v29, v8 quad_perm:[2,2,2,2] row_mask:0xf bank_mask:0xf
    v_and_b32_dpp v33, v29, v9 quad_perm:[2,2,2,2] row_mask:0xf bank_mask:0xf
    s_add_u32 s42, s42, 8192
    buffer_load_dwordx4 a[136:139], v58, s[68:71], s42 offen offset:0 nt
    v_cvt_pk_bf16_f32 v28, v12, v12
    v_add_f32 v11, v11, v12
L_w32:
    s_cbranch_execz L_w33
    v_mfma_f32_16x16x16_bf16 v[16:19], v[32:33], a[88:89], v[16:19]
    v_mfma_f32_16x16x16_bf16 v[20:23], v[32:33], a[90:91], v[20:23]
    v_and_b32_dpp v34, v29, v8 quad_perm:[3,3,3,3] row_mask:0xf bank_mask:0xf
    v_and_b32_dpp v35, v29, v9 quad_perm:[3,3,3,3] row_mask:0xf bank_mask:0xf
    s_nop 0
    buffer_load_dwordx4 a[140:143], v58, s[68:71], s42 offen offset:1024 nt
    v_mfma_f32_16x16x16_bf16 v[16:19], v[34:35], a[92:93], v[16:19]
    v_mfma_f32_16x16x16_bf16 v[20:23], v[34:35], a[94:95], v[20:23]
    v_and_b32_dpp v32, v28, v8 quad_perm:[0,0,0,0] row_mask:0xf bank_mask:0xf
    v_and_b32_dpp v33, v28, v9 quad_perm:[0,0,0,0] row_mask:0xf bank_mask:0xf
    s_add_u32 s42, s42, 8192
    buffer_load_dwordx4 a[144:147], v58, s[68:71], s42 offen offset:0 nt
L_w33:
    s_cbranch_execz L_w34
    v_mfma_f32_16x16x16_bf16 v[16:19], v[32:33], a[96:97], v[16:19]
    v_mfma_f32_16x16x16_bf16 v[20:23], v[32:33], a[98:99], v[20:23]
    v_and_b32_dpp v34, v28, v8 quad_perm:[1,1,1,1] row_mask:0xf bank_mask:0xf
    v_and_b32_dpp v35, v28, v9 quad_perm:[1,1,1,1] row_mask:0xf bank_mask:0xf
    s_nop 0
    buffer_load_dwordx4 a[148:151], v58, s[68:71], s42 offen offset:1024 nt
    v_fma_f32 v12, v71, s45, -v10
    v_exp_f32 v12, v12
    v_mfma_f32_16x16x16_bf16 v[16:19], v[34:35], a[100:101], v[16:19]
    v_mfma_f32_16x16x16_bf16 v[20:23], v[34:35], a[102:103], v[20:23]
    v_and_b32_dpp v32, v28, v8 quad_perm:[2,2,2,2] row_mask:0xf bank_mask:0xf
    v_and_b32_dpp v33, v28, v9 quad_perm:[2,2,2,2] row_mask:0xf bank_mask:0xf
    s_add_u32 s42, s42, 8192
    buffer_load_dwordx4 a[152:155], v58, s[68:71], s42 offen offset:0 nt
    v_cvt_pk_bf16_f32 v29, v12, v12
    v_add_f32 v11, v11, v12
L_w34:
    s_cbranch_execz L_w35
    s_waitcnt vmcnt(12)
    v_mfma_f32_16x16x16_bf16 v[16:19], v[32:33], a[104:105], v[16:19]
    v_mfma_f32_16x16x16_bf16 v[20:23], v[32:33], a[106:107], v[20:23]
    v_and_b32_dpp v34, v28, v8 quad_perm:[3,3,3,3] row_mask:0xf bank_mask:0xf
    v_and_b32_dpp v35, v28, v9 quad_perm:[3,3,3,3] row_mask:0xf bank_mask:0xf
    s_nop 0
    buffer_load_dwordx4 a[156:159], v58, s[68:71], s42 offen offset:1024 nt
    s_waitcnt vmcnt(12)
    v_mfma_f32_16x16x16_bf16 v[16:19], v[34:35], a[108:109], v[16:19]
    v_mfma_f32_16x16x16_bf16 v[20:23], v[34:35], a[110:111], v[20:23]
    v_and_b32_dpp v32, v29, v8 quad_perm:[0,0,0,0] row_mask:0xf bank_mask:0xf
    v_and_b32_dpp v33, v29, v9 quad_perm:[0,0,0,0] row_mask:0xf bank_mask:0xf
    v_add_f32_dpp v11, v11, v11 quad_perm:[1,0,3,2] row_mask:0xf bank_mask:0xf
    s_nop 1
    v_add_f32_dpp v11, v11, v11 quad_perm:[2,3,0,1] row_mask:0xf bank_mask:0xf
    v_mov_b32 v12, v11
    s_nop 1
    v_permlane16_swap_b32 v12, v11
    v_add_f32 v11, v11, v12
    v_mov_b32 v12, v11
    s_nop 1
    v_permlane32_swap_b32 v12, v11
    v_add_f32 v11, v11, v12
    ds_write_b64 v61, v[10:11] offset:24576
L_w35:
    s_cbranch_execz L_w36
    s_waitcnt vmcnt(11)
    v_mfma_f32_16x16x16_bf16 v[16:19], v[32:33], a[112:113], v[16:19]
    v_mfma_f32_16x16x16_bf16 v[20:23], v[32:33], a[114:115], v[20:23]
    v_and_b32_dpp v34, v29, v8 quad_perm:[1,1,1,1] row_mask:0xf bank_mask:0xf
    v_and_b32_dpp v35, v29, v9 quad_perm:[1,1,1,1] row_mask:0xf bank_mask:0xf
    s_nop 1
    s_waitcnt vmcnt(10)
    v_mfma_f32_16x16x16_bf16 v[16:19], v[34:35], a[116:117], v[16:19]
    v_mfma_f32_16x16x16_bf16 v[20:23], v[34:35], a[118:119], v[20:23]
    v_and_b32_dpp v32, v29, v8 quad_perm:[2,2,2,2] row_mask:0xf bank_mask:0xf
    v_and_b32_dpp v33, v29, v9 quad_perm:[2,2,2,2] row_mask:0xf bank_mask:0xf
    s_nop 1
L_w36:
    s_cbranch_execz L_w37
    s_waitcnt vmcnt(9)
    v_mfma_f32_16x16x16_bf16 v[16:19], v[32:33], a[120:121], v[16:19]
    v_mfma_f32_16x16x16_bf16 v[20:23], v[32:33], a[122:123], v[20:23]
    v_and_b32_dpp v34, v29, v8 quad_perm:[3,3,3,3] row_mask:0xf bank_mask:0xf
    v_and_b32_dpp v35, v29, v9 quad_perm:[3,3,3,3] row_mask:0xf bank_mask:0xf
    s_nop 1
    s_waitcnt vmcnt(8)
    v_mfma_f32_16x16x16_bf16 v[16:19], v[34:35], a[124:125], v[16:19]
    v_mfma_f32_16x16x16_bf16 v[20:23], v[34:35], a[126:127], v[20:23]
L_w37:
    s_cbranch_execz L_w38
    s_nop 5
    ds_write2_b32 v60, v16, v17 offset0:0 offset1:1
    ds_write2_b32 v60, v18, v19 offset0:2 offset1:16
    ds_write2_b32 v60, v20, v21 offset0:17 offset1:18
    ds_write2_b32 v60, v22, v23 offset0:32 offset1:33
    s_waitcnt lgkmcnt(0)
    s_barrier
    ds_read_b128 v[16:19], v62 offset:24576
    ds_read_b128 v[20:23], v62 offset:24592
    ds_read_b128 v[32:35], v63 offset:0
    ds_read_b128 v[36:39], v63 offset:3072
    ds_read_b128 v[40:43], v63 offset:6144
    ds_read_b128 v[44:47], v63 offset:9216
    s_waitcnt lgkmcnt(4)
    v_max3_f32 v24, v16, v18, v20
    v_max_f32 v24, v24, v22
    v_sub_f32 v16, v16, v24
    v_sub_f32 v18, v18, v24
    v_sub_f32 v20, v20, v24
    v_sub_f32 v22, v22, v24
    v_exp_f32 v16, v16
    v_exp_f32 v18, v18
    v_exp_f32 v20, v20
    v_exp_f32 v22, v22
    v_mul_f32 v25, v16, v17
    v_fmac_f32 v25, v18, v19
    v_fmac_f32 v25, v20, v21
    v_fmac_f32 v25, v22, v23
    v_rcp_f32 v26, v25
    v_log_f32 v27, v25
L_w38:
    s_cbranch_execz L_w39
    s_waitcnt lgkmcnt(0)
    v_mul_f32 v28, v16, v32
    v_mul_f32 v29, v16, v33
    v_mul_f32 v30, v16, v34
    v_fmac_f32 v28, v18, v36
    v_fmac_f32 v29, v18, v37
    v_fmac_f32 v30, v18, v38
    v_fmac_f32 v28, v20, v40
    v_fmac_f32 v29, v20, v41
    v_fmac_f32 v30, v20, v42
    v_fmac_f32 v28, v22, v44
    v_fmac_f32 v29, v22, v45
    v_fmac_f32 v30, v22, v46
    v_add_f32 v27, v27, v24
    v_mul_f32 v28, v28, v26
    v_mul_f32 v29, v29, v26
    v_mul_f32 v30, v30, v26
    v_cndmask_b32 v30, v30, v27, s[58:59]
    s_mov_b32 exec_hi, 0xffff
    s_cmp_lg_u32 s10, 1
    s_cbranch_scc1 L_bs
    buffer_store_dwordx4 v[28:31], v3, s[32:35], s36 offen
    s_branch L_bd
L_bs:
    buffer_store_dwordx4 v[28:31], v3, s[32:35], s36 offen sc1
L_bd:
    s_mov_b64 exec, -1
L_w39:
    s_cbranch_execz L_w40
L_h1:
    buffer_load_dwordx4 v[72:75], v56, s[32:35], s37 offen offset:0 sc1
    buffer_load_dwordx4 v[76:79], v56, s[32:35], s37 offen offset:64 sc1
    buffer_load_dwordx4 v[80:83], v56, s[32:35], s37 offen offset:128 sc1
    buffer_load_dwordx4 v[84:87], v56, s[32:35], s38 offen offset:0 sc1
    buffer_load_dwordx4 v[88:91], v56, s[32:35], s38 offen offset:64 sc1
    buffer_load_dwordx4 v[92:95], v56, s[32:35], s38 offen offset:128 sc1
    s_sub_u32 s39, s39, 1
    s_cmp_eq_u32 s39, 0
    s_cbranch_scc1 L_h1d
    s_waitcnt vmcnt(0)
L_h1c:
    v_max3_u32 v32, v75, v79, v83
    v_min3_u32 v33, v75, v79, v83
    v_max3_u32 v32, v32, v87, v91
    v_min3_u32 v33, v33, v87, v91
    v_max3_u32 v32, v32, v95, v31
    v_min3_u32 v33, v33, v95, v31
    v_cmp_ne_u32 vcc, v32, v33
    s_and_b64 exec, exec, vcc
    s_cbranch_execnz L_h1
L_h1d:
    s_mov_b64 exec, -1
    s_waitcnt vmcnt(0)
    v_max_f32 v32, v82, v94
    s_nop 0
L_w40:
    s_cbranch_execz L_w41
    v_max_f32_dpp v32, v32, v32 row_ror:4 row_mask:0xf bank_mask:0xf
    s_nop 1
    v_max_f32_dpp v32, v32, v32 row_ror:8 row_mask:0xf bank_mask:0xf
    v_mov_b32 v33, v32
    s_nop 1
    v_permlane16_swap_b32 v33, v32
    v_max_f32 v32, v32, v33
    v_mov_b32 v33, v32
    s_nop 1
    v_permlane32_swap_b32 v33, v32
    v_max_f32 v32, v32, v33
    v_sub_f32 v34, v82, v32
    v_sub_f32 v35, v94, v32
    v_exp_f32 v34, v34
    v_exp_f32 v35, v35
    v_mul_f32 v72, v72, v34
    v_mul_f32 v73, v73, v34
    v_mul_f32 v74, v74, v34
    v_mul_f32 v76, v76, v34
    v_mul_f32 v77, v77, v34
    v_mul_f32 v78, v78, v34
    v_mul_f32 v80, v80, v34
    v_mul_f32 v81, v81, v34
    v_add_f32 v32, v34, v35
    v_add_f32 v33, v34, v35
L_w41:
    s_cbranch_execz L_w42
    v_fmac_f32 v72, v84, v35
    v_fmac_f32 v73, v85, v35
    v_fmac_f32 v74, v86, v35
    v_fmac_f32 v76, v88, v35
    v_fmac_f32 v77, v89, v35
    v_fmac_f32 v78, v90, v35
    v_fmac_f32 v80, v92, v35
    v_fmac_f32 v81, v93, v35
    v_permlane32_swap_b32 v33, v32
    v_permlane32_swap_b32 v72, v77
    v_permlane32_swap_b32 v73, v78
    v_permlane32_swap_b32 v74, v80
    v_permlane32_swap_b32 v76, v81
    v_add_f32 v32, v32, v33
    v_add_f32 v72, v72, v77
    v_add_f32 v73, v73, v78
    v_add_f32 v74, v74, v80
    v_add_f32 v76, v76, v81
    v_mov_b32 v33, v32
L_w42:
    s_cbranch_execz L_w43
    v_permlane16_swap_b32 v72, v74
    v_permlane16_swap_b32 v73, v76
    v_permlane16_swap_b32 v33, v32
    v_add_f32 v72, v72, v74
    v_add_f32 v73, v73, v76
    v_add_f32 v32, v32, v33
    v_add_f32_dpp v72, v72, v72 row_ror:4 row_mask:0xf bank_mask:0xf
    v_add_f32_dpp v73, v73, v73 row_ror:4 row_mask:0xf bank_mask:0xf
    v_add_f32_dpp v32, v32, v32 row_ror:4 row_mask:0xf bank_mask:0xf
    v_add_f32_dpp v72, v72, v72 row_ror:8 row_mask:0xf bank_mask:0xf
    v_add_f32_dpp v73, v73, v73 row_ror:8 row_mask:0xf bank_mask:0xf
    v_add_f32_dpp v32, v32, v32 row_ror:8 row_mask:0xf bank_mask:0xf
    v_rcp_f32 v32, v32
L_w43:
    s_cbranch_execz L_w44
    v_mul_f32 v64, v72, v32
    v_mul_f32 v65, v73, v32
    v_cvt_pk_bf16_f32 v64, v64, v64
    v_cvt_pk_bf16_f32 v65, v65, v65
    v_lshlrev_b32 v60, 5, v1
    s_lshl_b32 s36, s20, 9
    v_add_u32 v60, s36, v60
    v_and_b32_dpp v40, v64, v8 quad_perm:[0,0,0,0] row_mask:0xf bank_mask:0xf
    v_and_b32_dpp v41, v64, v9 quad_perm:[0,0,0,0] row_mask:0xf bank_mask:0xf
    v_and_b32_dpp v42, v65, v8 quad_perm:[0,0,0,0] row_mask:0xf bank_mask:0xf
    v_and_b32_dpp v43, v65, v9 quad_perm:[0,0,0,0] row_mask:0xf bank_mask:0xf
    v_mfma_f32_16x16x16_bf16 v[24:27], v[40:41], a[128:129], 0
    v_mfma_f32_16x16x16_bf16 v[20:23], v[40:41], a[130:131], 0
    v_and_b32_dpp v44, v64, v8 quad_perm:[1,1,1,1] row_mask:0xf bank_mask:0xf
    v_and_b32_dpp v45, v64, v9 quad_perm:[1,1,1,1] row_mask:0xf bank_mask:0xf
    v_mfma_f32_16x16x16_bf16 v[24:27], v[42:43], a[132:133], v[24:27]
    v_mfma_f32_16x16x16_bf16 v[20:23], v[42:43], a[134:135], v[20:23]
    v_and_b32_dpp v46, v65, v8 quad_perm:[1,1,1,1] row_mask:0xf bank_mask:0xf
    v_and_b32_dpp v47, v65, v9 quad_perm:[1,1,1,1] row_mask:0xf bank_mask:0xf
    v_mfma_f32_16x16x16_bf16 v[24:27], v[44:45], a[136:137], v[24:27]
    v_mfma_f32_16x16x16_bf16 v[20:23], v[44:45], a[138:139], v[20:23]
    v_and_b32_dpp v48, v64, v8 quad_perm:[2,2,2,2] row_mask:0xf bank_mask:0xf
    v_and_b32_dpp v49, v64, v9 quad_perm:[2,2,2,2] row_mask:0xf bank_mask:0xf
L_w44:
    s_cbranch_execz L_w45
    v_mfma_f32_16x16x16_bf16 v[24:27], v[46:47], a[140:141], v[24:27]
    v_mfma_f32_16x16x16_bf16 v[20:23], v[46:47], a[142:143], v[20:23]
    v_and_b32_dpp v50, v65, v8 quad_perm:[2,2,2,2] row_mask:0xf bank_mask:0xf
    v_and_b32_dpp v51, v65, v9 quad_perm:[2,2,2,2] row_mask:0xf bank_mask:0xf
    v_mfma_f32_16x16x16_bf16 v[24:27], v[48:49], a[144:145], v[24:27]
    v_mfma_f32_16x16x16_bf16 v[20:23], v[48:49], a[146:147], v[20:23]
    v_and_b32_dpp v52, v64, v8 quad_perm:[3,3,3,3] row_mask:0xf bank_mask:0xf
    v_and_b32_dpp v53, v64, v9 quad_perm:[3,3,3,3] row_mask:0xf bank_mask:0xf
    v_mfma_f32_16x16x16_bf16 v[24:27], v[50:51], a[148:149], v[24:27]
    v_mfma_f32_16x16x16_bf16 v[20:23], v[50:51], a[150:151], v[20:23]
    v_and_b32_dpp v54, v65, v8 quad_perm:[3,3,3,3] row_mask:0xf bank_mask:0xf
    v_and_b32_dpp v55, v65, v9 quad_perm:[3,3,3,3] row_mask:0xf bank_mask:0xf
    v_mfma_f32_16x16x16_bf16 v[24:27], v[52:53], a[152:153], v[24:27]
    v_mfma_f32_16x16x16_bf16 v[20:23], v[52:53], a[154:155], v[20:23]
L_w45:
    s_cbranch_execz L_w46
    v_mfma_f32_16x16x16_bf16 v[24:27], v[54:55], a[156:157], v[24:27]
    v_mfma_f32_16x16x16_bf16 v[20:23], v[54:55], a[158:159], v[20:23]
    s_lshl_b32 s36, s60, 12
    s_and_b32 s37, s4, 3
    s_lshl_b32 s37, s37, 10
    s_add_u32 s36, s36, s37
    s_add_u32 s36, s36, 262144
    v_lshlrev_b32 v61, 3, v1
    v_mov_b32 v29, v31
    v_lshrrev_b32 v62, 1, v1
    v_lshlrev_b32 v62, 12, v62
    v_and_b32 v63, 1, v1
    v_lshl_add_u32 v62, v63, 4, v62
    s_mov_b64 exec, 0xffff
    ds_write_b128 v60, v[24:27] offset:26880
    ds_write_b128 v60, v[20:23] offset:26896
    s_mov_b64 exec, -1
L_w46:
    s_cbranch_execz L_w47
    s_lshl_b32 s38, s3, 4
    s_and_b32 s37, s4, 15
    s_add_u32 s38, s38, s37
    s_lshl_b32 s37, s5, 17
    s_lshl_b32 s39, s38, 5
    s_add_u32 s37, s37, s39
    s_add_u32 s37, s37, 262144
    s_waitcnt lgkmcnt(0)
    s_barrier
    s_cmp_lg_u32 s20, 0
    s_cbranch_scc1 L_fin
    ds_read_b64 v[32:33], v61 offset:26880
    ds_read_b64 v[34:35], v61 offset:27392
    ds_read_b64 v[36:37], v61 offset:27904
    ds_read_b64 v[38:39], v61 offset:28416
    v_lshrrev_b32 v60, 5, v1
    v_lshlrev_b32 v60, 1, v60
    v_lshl_add_u32 v60, v63, 2, v60
    s_lshl_b32 s38, s38, 3
    s_lshl_b32 s39, s5, 10
    s_add_u32 s38, s38, s39
    s_mov_b32 s39, 200000
    s_waitcnt lgkmcnt(0)
    v_add_f32 v32, v32, v34
    v_add_f32 v33, v33, v35
    v_add_f32 v36, v36, v38
    v_add_f32 v37, v37, v39
    v_add_f32 v28, v32, v36
    v_add_f32 v30, v33, v37
    buffer_store_dwordx4 v[28:31], v3, s[32:35], s36 offen sc1
L_w47:
    s_cbranch_execz L_w48
    s_waitcnt vmcnt(0)
L_h2:
    buffer_load_dwordx4 v[20:23], v62, s[32:35], s37 offen sc1
    s_sub_u32 s39, s39, 1
    s_cmp_eq_u32 s39, 0
    s_cbranch_scc1 L_h2d
    s_waitcnt vmcnt(0)
    v_xor_b32 v32, v21, v31
    v_xor_b32 v33, v23, v31
    v_or_b32 v32, v32, v33
    v_cmp_ne_u32 vcc, 0, v32
    s_and_b64 exec, exec, vcc
    s_cbranch_execnz L_h2
L_h2d:
    s_mov_b64 exec, -1
    s_waitcnt vmcnt(0)
    v_permlane32_swap_b32 v20, v22
    v_add_f32 v20, v20, v22
    v_mov_b32 v21, v20
    s_nop 1
    v_permlane16_swap_b32 v21, v20
    v_add_f32 v20, v20, v21
    s_nop 1
    v_add_f32_dpp v20, v20, v20 row_ror:8 row_mask:0xf bank_mask:0xf
    s_nop 1
    v_add_f32_dpp v20, v20, v20 row_ror:4 row_mask:0xf bank_mask:0xf
    s_nop 1
    v_add_f32_dpp v20, v20, v20 row_ror:2 row_mask:0xf bank_mask:0xf
L_w48:
    s_cbranch_execz L_w49
    v_cvt_pk_bf16_f32 v20, v20, v20
    s_mov_b32 exec_lo, 3
    s_mov_b32 exec_hi, 3
    buffer_store_short v20, v60, s[76:79], s38 offen
    s_cmp_lg_u32 s2, 0
    s_cbranch_scc1 L_fin
    s_mov_b64 exec, 1
    s_mov_b32 s36, 65536
    buffer_store_dword v31, v3, s[32:35], s36 offen sc1
L_fin:
L_end:
    s_endpgm
.set CODE_LAST, L_end-concat_heads__gqa_block_cached__gqa_block_cached__decode_kernel
.set L_w49, L_h2nd
.section .rodata,"a"
.p2align 6
.amdhsa_kernel concat_heads__gqa_block_cached__gqa_block_cached__decode_kernel
  .amdhsa_next_free_vgpr 256
  .amdhsa_next_free_sgpr 100
  .amdhsa_accum_offset 96
  .amdhsa_group_segment_fixed_size 0
  .amdhsa_kernarg_size 104
  .amdhsa_user_sgpr_count 2
  .amdhsa_user_sgpr_kernarg_segment_ptr 1
  .amdhsa_system_sgpr_workgroup_id_x 1
.end_amdhsa_kernel
```
